```python
import torch

def _softmax(x, axis=-1):
    return torch.softmax(x, dim=axis)
def _gelu(x):
    return torch.nn.functional.gelu(x, approximate="tanh")
def _silu(x):
    return torch.nn.functional.silu(x)
def _sigmoid(x):
    return torch.sigmoid(x)
def _layernorm(x, axis=-1, eps=1e-5):
    m = x.mean(dim=axis, keepdim=True)
    v = x.var(dim=axis, keepdim=True, unbiased=False)
    return (x - m) / torch.sqrt(v + eps)
def _scatter_add(tgt, idx, src, axis=0):
    return tgt.clone().index_add_(axis, idx, src)
def _segment_sum(src, seg, n):
    out = torch.zeros((n,) + src.shape[1:], dtype=src.dtype)
    return out.index_add_(0, seg, src)
def _pad(x, pw):
    flat = tuple(v for pair in reversed(pw) for v in pair)
    return torch.nn.functional.pad(x, flat)

kernel_name = 'gated_mix__ssm_conv_s4__mha_block__prompt'

def setup_inputs():

    _w = (lambda a: (lambda t: t.to(torch.bfloat16) if t.is_floating_point() else t)(torch.as_tensor(a)))
    def _A_setup():
        B, L, D, N = 1, 2048, 512, 128
        A_re = -(lambda _x: torch.exp(torch.as_tensor(_x)))((lambda *s: torch.randn(*s, dtype=torch.bfloat16) * 6.4)(D, N))
        A_im = torch.pi * (lambda *s: torch.randn(*s, dtype=torch.bfloat16) * 0.1)(D, N)
        B_re = (lambda *s: torch.randn(*s, dtype=torch.bfloat16) * 0.2)(D, N)
        B_im = (lambda *s: torch.randn(*s, dtype=torch.bfloat16) * 0.2)(D, N)
        C_re = (lambda *s: torch.randn(*s, dtype=torch.bfloat16) * 0.2)(D, N)
        C_im = (lambda *s: torch.randn(*s, dtype=torch.bfloat16) * 0.2)(D, N)
        log_dt = (lambda *s: torch.randn(*s, dtype=torch.bfloat16) * 0.1)(D) * 0.5 - 4.0
        Dskip = (lambda *s: torch.randn(*s, dtype=torch.bfloat16) * 0.1)(D)
        return {
            "u": _w((lambda *s: torch.randn(*s, dtype=torch.bfloat16) * 0.05)(B, L, D)),
            "A_re": _w(A_re),
            "A_im": _w(A_im),
            "B_re": _w(B_re),
            "B_im": _w(B_im),
            "C_re": _w(C_re),
            "C_im": _w(C_im),
            "log_dt": _w(log_dt),
            "Dskip": _w(Dskip),
        }
    _A_in = _A_setup()

    def _B_setup():
        B, S, D, H = 1, 2048, 512, 32
        return {
            "x": _w((lambda *s: torch.randn(*s, dtype=torch.bfloat16) * 0.05)(B, S, D)),
            "wqkv": _w((lambda *s: torch.randn(*s, dtype=torch.bfloat16) * 0.8)(D, 3 * D)),
            "wo": _w((lambda *s: torch.randn(*s, dtype=torch.bfloat16) * 0.05)(D, D)),
        }
    _B_in = _B_setup()

    return {
        "A_u": _A_in["u"],
        "A_A_re": _A_in["A_re"],
        "A_A_im": _A_in["A_im"],
        "A_B_re": _A_in["B_re"],
        "A_B_im": _A_in["B_im"],
        "A_C_re": _A_in["C_re"],
        "A_C_im": _A_in["C_im"],
        "A_log_dt": _A_in["log_dt"],
        "A_Dskip": _A_in["Dskip"],
        "B_x": _B_in["x"],
        "B_wqkv": _B_in["wqkv"],
        "B_wo": _B_in["wo"],
        "gate_w": _w((lambda *s: torch.randn(*s, dtype=torch.bfloat16) * 0.05)(512) * 16.0),
    }

def reference(A_u, A_A_re, A_A_im, A_B_re, A_B_im, A_C_re, A_C_im, A_log_dt, A_Dskip, B_x, B_wqkv, B_wo, gate_w):
    def _A_ref(u, A_re, A_im, B_re, B_im, C_re, C_im, log_dt, Dskip):
        Bsz, L, D = u.shape
        dt = torch.exp(log_dt)[:, None]
        A = A_re + 1j * A_im
        Bc = B_re + 1j * B_im
        Cc = C_re + 1j * C_im
        logdA = dt * A
        dB = dt * Bc
        l = (lambda x, dt: x.to(dt))(torch.arange(L), A_re.dtype)
        P = torch.exp(logdA[:, :, None] * l[None, None, :])
        K = torch.einsum("dn,dnl,dn->dl", Cc, P, dB).real
        L2 = 2 * L
        Kp = _pad(K, ((0, 0), (0, L)))
        up = (lambda x, *d: x.permute(*d))(u, 0, 2, 1)
        up = _pad(up, ((0, 0), (0, 0), (0, L)))
        Kf = (lambda x, axes=(-2,-1): torch.fft.rfft2(x.float(), dim=axes))(Kp[:, None, :], axes=(-2, -1))
        Uf = (lambda x, axes=(-2,-1): torch.fft.rfft2(x.float(), dim=axes))(up[:, :, None, :], axes=(-2, -1))
        Yf = Uf * Kf[None, :, :, :]
        y = (lambda x, s, axes=(-2,-1): torch.fft.irfft2(x, s=s, dim=axes).to(torch.bfloat16))(Yf, (1, L2), axes=(-2, -1))[:, :, 0, :L]
        y = (lambda x, *d: x.permute(*d))(y, 0, 2, 1) + u * Dskip[None, None, :]
        return y

    def _B_ref(x, wqkv, wo):
        B, S, D = x.shape
        H = 32
        Dh = D // H
        qkv = (lambda x, *d: x.permute(*d))((x @ wqkv).reshape(B, S, 3, H, Dh), 2, 0, 3, 1, 4)
        q, k, v = qkv[0], qkv[1], qkv[2]
        scores = torch.einsum("bhqd,bhkd->bhqk", q, k) * (Dh ** -0.5)
        p = _softmax(scores, axis=-1)
        o = torch.einsum("bhqk,bhkd->bhqd", p, v)
        return (lambda x, *d: x.permute(*d))(o, 0, 2, 1, 3).reshape(B, S, D) @ wo

    x = A_u
    g = _sigmoid((x * gate_w).sum(-1, keepdims=True))
    a = _A_ref(x, A_A_re, A_A_im, A_B_re, A_B_im, A_C_re, A_C_im, A_log_dt, A_Dskip)
    b = _B_ref(x, B_wqkv, B_wo)
    return g * a + (1 - g) * b
```

```asm
; @launch grid=(256,1,1) block=(512,1,1) lds=153600
.amdgcn_target "amdgcn-amd-amdhsa--gfx950"
.text
.globl gated_mix__ssm_conv_s4__mha_block__prompt_kernel
.p2align 12
.p2align 8
.type gated_mix__ssm_conv_s4__mha_block__prompt_kernel,@function
gated_mix__ssm_conv_s4__mha_block__prompt_kernel:
    s_cmpk_ge_u32 s2, 0x100
    s_cbranch_scc1 L_end
    s_load_dwordx16 s[16:31], s[0:1], 0
    s_load_dwordx16 s[32:47], s[0:1], 64
    v_lshrrev_b32 v2, 6, v0
    v_and_b32 v1, 63, v0
    v_readfirstlane_b32 s3, v2
    s_bfe_u32 s4, s2, 0x20003
    s_and_b32 s48, s2, 3
    s_lshl2_add_u32 s4, s48, s4
    s_lshr_b32 s5, s2, 5
    s_and_b32 s48, s2, 4
    s_lshl1_add_u32 s5, s48, s5
    s_add_u32 s7, s4, s5
    s_lshl_b32 s7, s7, 1
    s_and_b32 s7, s7, 6
    s_cmp_lt_u32 s3, 4
    s_cbranch_scc1 L_m0
L_h0:
    s_setprio 2
    s_sub_u32 s48, s3, 4
    s_getpc_b64 s[8:9]
L_pc:
    s_andn2_b32 s10, s2, 7
    s_lshl1_add_u32 s10, s48, s10
    v_and_b32 v2, 1, v1
    v_add_lshl_u32 v2, v2, s10, 7
    v_min_u32 v2, L_end-L_pc, v2
    v_mov_b32 v3, 0
    v_lshl_add_u64 v[2:3], v[2:3], 0, s[8:9]
    global_load_dword v167, v[2:3], off
    s_lshl4_add_u32 s6, s4, s5
    s_lshl2_add_u32 s56, s6, s48
    s_lshl_b32 s56, s56, 7
    v_lshl_add_u32 v2, v1, 1, s56
    s_lshl_b32 s57, s6, 2
    s_waitcnt lgkmcnt(0)
    s_load_dword s54, s[30:31], s57
    s_load_dword s55, s[32:33], s57
    global_load_ushort v4, v2, s[18:19]
    global_load_ushort v5, v2, s[20:21]
    global_load_ushort v6, v2, s[22:23]
    global_load_ushort v7, v2, s[24:25]
    global_load_ushort v8, v2, s[26:27]
    global_load_ushort v9, v2, s[28:29]
    s_and_b32 s50, s48, 1
    s_lshl_b32 s6, s6, 1
    s_branch L_helper
L_m0:
    s_lshl2_add_u32 s48, s5, s3
    s_lshl_b32 s48, s48, 15
    v_lshrrev_b32 v2, 3, v1
    v_lshl_add_u32 v2, v2, 10, s48
    v_lshrrev_b32 v3, 4, v1
    v_xor_b32 v3, v3, v1
    v_and_b32 v3, 7, v3
    v_lshl_add_u32 v4, v3, 4, v2
    v_xor_b32 v5, 64, v4
    s_movk_i32 s48, 7168
    v_add_u32 v5, s48, v5
    s_movk_i32 s48, 14336
    v_add_u32 v6, s48, v4
    v_add_u32 v7, s48, v5
    v_lshrrev_b32 v2, 2, v0
    v_mul_u32_u24 v2, 3072, v2
    v_lshrrev_b32 v3, 4, v1
    v_and_b32 v3, 2, v3
    v_xor_b32 v3, v3, v1
    v_and_b32 v3, 3, v3
    s_lshl2_add_u32 s48, s4, 64
    v_add_u32 v3, s48, v3
    v_lshl_add_u32 v8, v3, 4, v2
    s_mul_i32 s94, s3, 6144
    s_mov_b32 s10, 0x200000
    s_mov_b32 s11, 0x00020000
    s_mov_b32 s14, 0x180000
    s_mov_b32 s15, s11
    s_add_u32 m0, s94, 51200
    s_mul_i32 s93, s7, 196608
    s_waitcnt lgkmcnt(0)
    s_mov_b64 s[12:13], s[36:37]
    s_mov_b64 s[8:9], s[16:17]
    buffer_load_dwordx4 v8, s[12:15], s93 offen offset:0  lds
    buffer_load_dwordx4 v8, s[12:15], s93 offen offset:1024  lds
    s_add_u32 m0, s94, 47104
    s_lshl_b32 s92, s7, 7
    buffer_load_dwordx4 v4, s[8:11], s92 offen offset:0  lds
    buffer_load_dwordx4 v5, s[8:11], s92 offen offset:1024  lds
    buffer_load_dwordx4 v6, s[8:11], s92 offen offset:2048  lds
    buffer_load_dwordx4 v7, s[8:11], s92 offen offset:3072  lds
    v_subrev_u32 v9, 1024, v8
    s_lshl_b32 s27, s3, 10
    s_and_b32 s95, s3, 1
    s_lshl_b32 s48, s95, 10
    s_add_u32 m0, s48, 44992
    v_lshlrev_b32 v113, 4, v1
    global_load_lds_dwordx4 v113, s[40:41]
    s_add_u32 s48, s7, 1
    s_and_b32 s48, s48, 7
    s_add_u32 m0, s94, 75776
    s_mul_i32 s93, s48, 196608
    buffer_load_dwordx4 v8, s[12:15], s93 offen offset:0  lds
    buffer_load_dwordx4 v8, s[12:15], s93 offen offset:1024  lds
    s_add_u32 m0, s94, 71680
    s_lshl_b32 s92, s48, 7
    buffer_load_dwordx4 v4, s[8:11], s92 offen offset:0  lds
    s_add_u32 s34, s46, 8388608
    s_addc_u32 s35, s47, 0
    s_add_u32 s58, s94, 47104
    v_and_b32 v2, 15, v1
    v_lshl_add_u32 v2, v2, 7, s58
    v_bfe_u32 v3, v1, 1, 3
    v_lshrrev_b32 v11, 4, v1
    v_xor_b32 v3, v3, v11
    v_lshl_add_u32 v10, v3, 4, v2
    v_xor_b32 v11, 64, v10
    v_bfe_u32 v2, v1, 4, 1
    v_mul_u32_u24 v2, 544, v2
    v_bfe_u32 v3, v1, 2, 2
    v_lshl_add_u32 v2, v3, 6, v2
    v_and_b32 v3, 3, v1
    v_lshl_add_u32 v2, v3, 3, v2
    v_lshrrev_b32 v3, 5, v1
    v_lshl_add_u32 v16, v3, 10, v2
    v_add_u32 v16, 120832, v16
    v_xor_b32 v23, 32, v16
    v_mul_u32_u24 v3, 6144, v3
    v_add_u32 v2, v2, v3
    v_add_u32 v14, 51200, v2
    v_add_u32 v15, 100352, v2
    v_xor_b32 v12, 32, v14
    v_xor_b32 v13, 32, v15
    s_lshr_b32 s100, s3, 1
    s_mov_b32 s101, 0x3eb8aa3b
    s_lshl2_add_u32 s58, s5, s3
    s_lshl_b32 s58, s58, 11
    s_lshl_b32 s59, s4, 18
    s_add_u32 s58, s58, s59
    v_add_u32 v115, s58, v113
    v_add_u32 v116, 0x20000, v115
    v_and_b32 v114, 15, v1
    v_lshrrev_b32 v2, 5, v1
    v_lshl_add_u32 v114, v2, 4, v114
    v_lshlrev_b32 v114, 4, v114
    v_bfe_u32 v2, v1, 4, 1
    v_lshlrev_b32 v2, 17, v2
    v_add3_u32 v117, v2, v114, s58
    s_add_u32 s59, s94, 47104
    v_add_u32 v118, s59, v113
    s_lshl_b32 s58, s95, 10
    s_add_u32 s58, s58, 47104
    s_mul_i32 s59, s100, 12288
    s_add_u32 s60, s58, s59
    v_add_u32 v119, s60, v113
    s_sub_u32 s60, s58, s59
    s_add_u32 s60, s60, 12288
    v_add_u32 v120, s60, v113
    s_lshl_b32 s58, s95, 8
    s_add_u32 s60, s58, s59
    s_add_u32 s60, s60, 47104
    v_add_u32 v121, s60, v113
    s_lshl1_add_u32 s58, s4, s95
    s_lshl_b32 s59, s58, 17
    s_lshl_b32 s60, s100, 12
    s_add_u32 s59, s59, s60
    s_add_u32 s50, s46, s59
    s_addc_u32 s51, s47, 0
    s_lshl1_add_u32 s59, s5, s100
    s_lshl_b32 s59, s59, 6
    s_add_u32 s59, s59, s58
    s_lshl_b32 s59, s59, 10
    s_add_u32 s59, s59, 4194304
    v_add_u32 v126, s59, v113
    v_add_u32 v127, 0x8000, v126
    s_mul_i32 s58, s3, 4608
    s_add_u32 s58, s58, 120832
    v_add_u32 v122, s58, v113
    v_lshl_add_u32 v123, v1, 2, s58
    s_xor_b32 s58, s3, 2
    s_mul_i32 s58, s58, 4608
    s_add_u32 s58, s58, 120832
    v_add_u32 v124, s58, v113
    v_lshl_add_u32 v125, v1, 2, s58
    s_lshl4_add_u32 s58, s5, s4
    s_add_u32 s58, s58, 256
    s_lshl_b32 s58, s58, 8
    v_mov_b32 v19, s58
    v_mov_b32 v18, 1
    s_lshr_b32 s58, s4, 2
    s_lshl_b32 s58, s58, 3
    s_lshl_b32 s26, 1, s58
    s_lshl1_add_u32 s58, s5, s100
    s_lshl3_add_u32 s58, s58, 256
    v_add_lshl_u32 v17, v1, s58, 8
    s_lshl3_add_u32 s25, s3, 0x80000
    s_lshr_b32 s59, s4, 2
    s_lshl2_add_u32 s58, s5, s59
    s_lshl2_add_u32 s58, s58, s3
    s_lshl_b32 s58, s58, 13
    s_add_u32 s58, s58, 4194304
    v_add_u32 v20, s58, v113
    v_mov_b32 v112, 0xdddddddd
    v_and_b32 v2, 27, v1
    v_cmp_eq_u32 vcc, 16, v2
    v_mov_b32 v2, 47072
    v_mov_b32 v22, 47056
    s_mov_b32 s56, 0x0000ffff
    s_mov_b32 s57, 0x0000ffff
    v_cndmask_b32 v21, v22, v2, vcc
    s_mov_b32 s55, 8
    v_add_u32 v3, 4096, v20
    s_andn2_b32 s54, 8, s5
    s_lshl1_add_u32 s28, s54, s5
    s_sub_u32 s54, s54, 1
    s_add_u32 s54, s54, 1
    s_cmp_eq_u32 s54, s28
    s_addc_u32 s54, s54, 0
    s_lshl_b32 s29, s54, 13
    s_and_b32 s29, s29, 0x1e000
    s_add_u32 s52, s50, s29
    s_addc_u32 s53, s51, 0
    s_waitcnt vmcnt(6)
    buffer_load_dwordx4 v5, s[8:11], s92 offen offset:1024  lds
    buffer_load_dwordx4 v6, s[8:11], s92 offen offset:2048  lds
    buffer_load_dwordx4 v7, s[8:11], s92 offen offset:3072  lds
    s_waitcnt vmcnt(6)
    s_barrier
    ds_read_b128 v[128:131], v10 offset:0
    ds_read_b128 v[132:135], v10 offset:2048
    ds_read_b64_tr_b16 v[24:25], v14 offset:1024
    ds_read_b64_tr_b16 v[26:27], v14 offset:1280
    ds_read_b64_tr_b16 v[28:29], v12 offset:1024
    ds_read_b64_tr_b16 v[30:31], v12 offset:1280
    ds_read_b64_tr_b16 v[32:33], v14 offset:0
    ds_read_b64_tr_b16 v[34:35], v14 offset:256
    ds_read_b64_tr_b16 v[36:37], v12 offset:0
    ds_read_b64_tr_b16 v[38:39], v12 offset:256
    s_add_u32 s48, s7, 2
    s_and_b32 s48, s48, 7
    s_add_u32 m0, s94, 100352
    s_mul_i32 s93, s48, 196608
    buffer_load_dwordx4 v8, s[12:15], s93 offen offset:0  lds
    buffer_load_dwordx4 v8, s[12:15], s93 offen offset:1024  lds
    s_waitcnt lgkmcnt(4)
    v_mfma_f32_16x16x32_bf16 v[64:67], v[128:131], v[24:27], 0
    v_mfma_f32_16x16x32_bf16 v[72:75], v[132:135], v[24:27], 0
    ds_read_b128 v[136:139], v11 offset:0
    ds_read_b128 v[140:143], v11 offset:2048
    ds_read_b64_tr_b16 v[40:41], v14 offset:13312
    s_add_u32 m0, s94, 96256
    s_lshl_b32 s92, s48, 7
    buffer_load_dwordx4 v4, s[8:11], s92 offen offset:0  lds
    v_mfma_f32_16x16x32_bf16 v[68:71], v[128:131], v[28:31], 0
    v_mfma_f32_16x16x32_bf16 v[76:79], v[132:135], v[28:31], 0
    ds_read_b64_tr_b16 v[42:43], v14 offset:13568
    ds_read_b64_tr_b16 v[44:45], v12 offset:13312
    ds_read_b64_tr_b16 v[46:47], v12 offset:13568
    buffer_load_dwordx4 v5, s[8:11], s92 offen offset:1024  lds
    s_waitcnt lgkmcnt(6)
    v_mfma_f32_16x16x32_bf16 v[48:51], v[32:35], v[128:131], 0
    v_mfma_f32_16x16x32_bf16 v[52:55], v[32:35], v[132:135], 0
    ds_read_b64_tr_b16 v[24:25], v14 offset:12288
    ds_read_b64_tr_b16 v[26:27], v14 offset:12544
    ds_read_b64_tr_b16 v[28:29], v12 offset:12288
    buffer_load_dwordx4 v6, s[8:11], s92 offen offset:2048  lds
    v_mfma_f32_16x16x32_bf16 v[56:59], v[36:39], v[128:131], 0
    v_mfma_f32_16x16x32_bf16 v[60:63], v[36:39], v[132:135], 0
    ds_read_b64_tr_b16 v[30:31], v12 offset:12544
    buffer_load_dwordx4 v7, s[8:11], s92 offen offset:3072  lds
    s_waitcnt lgkmcnt(4)
    v_mfma_f32_16x16x32_bf16 v[64:67], v[136:139], v[40:43], v[64:67]
    v_mfma_f32_16x16x32_bf16 v[72:75], v[140:143], v[40:43], v[72:75]
    s_waitcnt vmcnt(6) lgkmcnt(0)
    s_barrier
    ds_read_b128 v[144:147], v10 offset:24576
    ds_read_b128 v[148:151], v10 offset:26624
    ds_read_b64_tr_b16 v[32:33], v14 offset:25600
    s_add_u32 s48, s7, 3
    s_and_b32 s48, s48, 7
    s_add_u32 m0, s94, 51200
    s_mul_i32 s93, s48, 196608
    buffer_load_dwordx4 v8, s[12:15], s93 offen offset:0  lds
    v_mfma_f32_16x16x32_bf16 v[68:71], v[136:139], v[44:47], v[68:71]
    v_mfma_f32_16x16x32_bf16 v[76:79], v[140:143], v[44:47], v[76:79]
    ds_read_b64_tr_b16 v[34:35], v14 offset:25856
    ds_read_b64_tr_b16 v[36:37], v12 offset:25600
    ds_read_b64_tr_b16 v[38:39], v12 offset:25856
    buffer_load_dwordx4 v8, s[12:15], s93 offen offset:1024  lds
    s_waitcnt lgkmcnt(6)
    v_mfma_f32_16x16x32_bf16 v[48:51], v[24:27], v[136:139], v[48:51]
    v_mfma_f32_16x16x32_bf16 v[52:55], v[24:27], v[140:143], v[52:55]
    ds_read_b64_tr_b16 v[40:41], v14 offset:24576
    ds_read_b64_tr_b16 v[42:43], v14 offset:24832
    ds_read_b64_tr_b16 v[44:45], v12 offset:24576
    s_add_u32 m0, s94, 47104
    s_lshl_b32 s92, s48, 7
    buffer_load_dwordx4 v4, s[8:11], s92 offen offset:0  lds
    v_mfma_f32_16x16x32_bf16 v[56:59], v[28:31], v[136:139], v[56:59]
    v_mfma_f32_16x16x32_bf16 v[60:63], v[28:31], v[140:143], v[60:63]
    ds_read_b64_tr_b16 v[46:47], v12 offset:24832
    buffer_load_dwordx4 v5, s[8:11], s92 offen offset:1024  lds
    s_waitcnt lgkmcnt(4)
    v_mfma_f32_16x16x32_bf16 v[64:67], v[144:147], v[32:35], v[64:67]
    v_mfma_f32_16x16x32_bf16 v[72:75], v[148:151], v[32:35], v[72:75]
    ds_read_b128 v[152:155], v11 offset:24576
    ds_read_b128 v[156:159], v11 offset:26624
    ds_read_b64_tr_b16 v[24:25], v14 offset:37888
    buffer_load_dwordx4 v6, s[8:11], s92 offen offset:2048  lds
    v_mfma_f32_16x16x32_bf16 v[68:71], v[144:147], v[36:39], v[68:71]
    v_mfma_f32_16x16x32_bf16 v[76:79], v[148:151], v[36:39], v[76:79]
    ds_read_b64_tr_b16 v[26:27], v14 offset:38144
    ds_read_b64_tr_b16 v[28:29], v12 offset:37888
    ds_read_b64_tr_b16 v[30:31], v12 offset:38144
    buffer_load_dwordx4 v7, s[8:11], s92 offen offset:3072  lds
    s_waitcnt lgkmcnt(6)
    v_mfma_f32_16x16x32_bf16 v[48:51], v[40:43], v[144:147], v[48:51]
    v_mfma_f32_16x16x32_bf16 v[52:55], v[40:43], v[148:151], v[52:55]
    ds_read_b64_tr_b16 v[32:33], v14 offset:36864
    ds_read_b64_tr_b16 v[34:35], v14 offset:37120
    ds_read_b64_tr_b16 v[36:37], v12 offset:36864
    v_mfma_f32_16x16x32_bf16 v[56:59], v[44:47], v[144:147], v[56:59]
    v_mfma_f32_16x16x32_bf16 v[60:63], v[44:47], v[148:151], v[60:63]
    ds_read_b64_tr_b16 v[38:39], v12 offset:37120
    s_waitcnt lgkmcnt(4)
    v_mfma_f32_16x16x32_bf16 v[64:67], v[152:155], v[24:27], v[64:67]
    v_mfma_f32_16x16x32_bf16 v[72:75], v[156:159], v[24:27], v[72:75]
    s_waitcnt vmcnt(6) lgkmcnt(0)
    s_barrier
    ds_read_b128 v[160:163], v10 offset:49152
    ds_read_b128 v[164:167], v10 offset:51200
    ds_read_b64_tr_b16 v[40:41], v15 offset:1024
    s_add_u32 s48, s7, 4
    s_and_b32 s48, s48, 7
    s_add_u32 m0, s94, 75776
    s_mul_i32 s93, s48, 196608
    buffer_load_dwordx4 v8, s[12:15], s93 offen offset:0  lds
    v_mfma_f32_16x16x32_bf16 v[68:71], v[152:155], v[28:31], v[68:71]
    v_mfma_f32_16x16x32_bf16 v[76:79], v[156:159], v[28:31], v[76:79]
    ds_read_b64_tr_b16 v[42:43], v15 offset:1280
    ds_read_b64_tr_b16 v[44:45], v13 offset:1024
    ds_read_b64_tr_b16 v[46:47], v13 offset:1280
    buffer_load_dwordx4 v8, s[12:15], s93 offen offset:1024  lds
    s_waitcnt lgkmcnt(6)
    v_mfma_f32_16x16x32_bf16 v[48:51], v[32:35], v[152:155], v[48:51]
    v_mfma_f32_16x16x32_bf16 v[52:55], v[32:35], v[156:159], v[52:55]
    ds_read_b64_tr_b16 v[24:25], v15 offset:0
    ds_read_b64_tr_b16 v[26:27], v15 offset:256
    ds_read_b64_tr_b16 v[28:29], v13 offset:0
    s_add_u32 m0, s94, 71680
    s_lshl_b32 s92, s48, 7
    buffer_load_dwordx4 v4, s[8:11], s92 offen offset:0  lds
    v_mfma_f32_16x16x32_bf16 v[56:59], v[36:39], v[152:155], v[56:59]
    v_mfma_f32_16x16x32_bf16 v[60:63], v[36:39], v[156:159], v[60:63]
    ds_read_b64_tr_b16 v[30:31], v13 offset:256
    buffer_load_dwordx4 v5, s[8:11], s92 offen offset:1024  lds
    s_waitcnt lgkmcnt(4)
    v_mfma_f32_16x16x32_bf16 v[64:67], v[160:163], v[40:43], v[64:67]
    v_mfma_f32_16x16x32_bf16 v[72:75], v[164:167], v[40:43], v[72:75]
    ds_read_b128 v[168:171], v11 offset:49152
    ds_read_b128 v[172:175], v11 offset:51200
    ds_read_b64_tr_b16 v[32:33], v15 offset:13312
    buffer_load_dwordx4 v6, s[8:11], s92 offen offset:2048  lds
    v_mfma_f32_16x16x32_bf16 v[68:71], v[160:163], v[44:47], v[68:71]
    v_mfma_f32_16x16x32_bf16 v[76:79], v[164:167], v[44:47], v[76:79]
    ds_read_b64_tr_b16 v[34:35], v15 offset:13568
    ds_read_b64_tr_b16 v[36:37], v13 offset:13312
    ds_read_b64_tr_b16 v[38:39], v13 offset:13568
    buffer_load_dwordx4 v7, s[8:11], s92 offen offset:3072  lds
    s_waitcnt lgkmcnt(6)
    v_mfma_f32_16x16x32_bf16 v[48:51], v[24:27], v[160:163], v[48:51]
    v_mfma_f32_16x16x32_bf16 v[52:55], v[24:27], v[164:167], v[52:55]
    ds_read_b64_tr_b16 v[40:41], v15 offset:12288
    ds_read_b64_tr_b16 v[42:43], v15 offset:12544
    ds_read_b64_tr_b16 v[44:45], v13 offset:12288
    v_mfma_f32_16x16x32_bf16 v[56:59], v[28:31], v[160:163], v[56:59]
    v_mfma_f32_16x16x32_bf16 v[60:63], v[28:31], v[164:167], v[60:63]
    ds_read_b64_tr_b16 v[46:47], v13 offset:12544
    s_waitcnt lgkmcnt(4)
    v_mfma_f32_16x16x32_bf16 v[64:67], v[168:171], v[32:35], v[64:67]
    v_mfma_f32_16x16x32_bf16 v[72:75], v[172:175], v[32:35], v[72:75]
    s_waitcnt vmcnt(6) lgkmcnt(0)
    s_barrier
    ds_read_b128 v[176:179], v10 offset:0
    ds_read_b128 v[180:183], v10 offset:2048
    ds_read_b64_tr_b16 v[24:25], v14 offset:1024
    s_add_u32 s48, s7, 5
    s_and_b32 s48, s48, 7
    s_add_u32 m0, s94, 100352
    s_mul_i32 s93, s48, 196608
    buffer_load_dwordx4 v8, s[12:15], s93 offen offset:0  lds
    v_mfma_f32_16x16x32_bf16 v[68:71], v[168:171], v[36:39], v[68:71]
    v_mfma_f32_16x16x32_bf16 v[76:79], v[172:175], v[36:39], v[76:79]
    ds_read_b64_tr_b16 v[26:27], v14 offset:1280
    ds_read_b64_tr_b16 v[28:29], v12 offset:1024
    ds_read_b64_tr_b16 v[30:31], v12 offset:1280
    buffer_load_dwordx4 v8, s[12:15], s93 offen offset:1024  lds
    s_waitcnt lgkmcnt(6)
    v_mfma_f32_16x16x32_bf16 v[48:51], v[40:43], v[168:171], v[48:51]
    v_mfma_f32_16x16x32_bf16 v[52:55], v[40:43], v[172:175], v[52:55]
    ds_read_b64_tr_b16 v[32:33], v14 offset:0
    ds_read_b64_tr_b16 v[34:35], v14 offset:256
    ds_read_b64_tr_b16 v[36:37], v12 offset:0
    s_add_u32 m0, s94, 96256
    s_lshl_b32 s92, s48, 7
    buffer_load_dwordx4 v4, s[8:11], s92 offen offset:0  lds
    v_mfma_f32_16x16x32_bf16 v[56:59], v[44:47], v[168:171], v[56:59]
    v_mfma_f32_16x16x32_bf16 v[60:63], v[44:47], v[172:175], v[60:63]
    ds_read_b64_tr_b16 v[38:39], v12 offset:256
    buffer_load_dwordx4 v5, s[8:11], s92 offen offset:1024  lds
    s_waitcnt lgkmcnt(4)
    v_mfma_f32_16x16x32_bf16 v[64:67], v[176:179], v[24:27], v[64:67]
    v_mfma_f32_16x16x32_bf16 v[72:75], v[180:183], v[24:27], v[72:75]
    ds_read_b128 v[184:187], v11 offset:0
    ds_read_b128 v[188:191], v11 offset:2048
    ds_read_b64_tr_b16 v[40:41], v14 offset:13312
    buffer_load_dwordx4 v6, s[8:11], s92 offen offset:2048  lds
    v_mfma_f32_16x16x32_bf16 v[68:71], v[176:179], v[28:31], v[68:71]
    v_mfma_f32_16x16x32_bf16 v[76:79], v[180:183], v[28:31], v[76:79]
    ds_read_b64_tr_b16 v[42:43], v14 offset:13568
    ds_read_b64_tr_b16 v[44:45], v12 offset:13312
    ds_read_b64_tr_b16 v[46:47], v12 offset:13568
    buffer_load_dwordx4 v7, s[8:11], s92 offen offset:3072  lds
    s_waitcnt lgkmcnt(6)
    v_mfma_f32_16x16x32_bf16 v[48:51], v[32:35], v[176:179], v[48:51]
    v_mfma_f32_16x16x32_bf16 v[52:55], v[32:35], v[180:183], v[52:55]
    ds_read_b64_tr_b16 v[24:25], v14 offset:12288
    ds_read_b64_tr_b16 v[26:27], v14 offset:12544
    ds_read_b64_tr_b16 v[28:29], v12 offset:12288
    v_mfma_f32_16x16x32_bf16 v[56:59], v[36:39], v[176:179], v[56:59]
    v_mfma_f32_16x16x32_bf16 v[60:63], v[36:39], v[180:183], v[60:63]
    ds_read_b64_tr_b16 v[30:31], v12 offset:12544
    s_waitcnt lgkmcnt(4)
    v_mfma_f32_16x16x32_bf16 v[64:67], v[184:187], v[40:43], v[64:67]
    v_mfma_f32_16x16x32_bf16 v[72:75], v[188:191], v[40:43], v[72:75]
    s_waitcnt vmcnt(6) lgkmcnt(0)
    s_barrier
    ds_read_b128 v[192:195], v10 offset:24576
    ds_read_b128 v[196:199], v10 offset:26624
    ds_read_b64_tr_b16 v[32:33], v14 offset:25600
    s_add_u32 s48, s7, 6
    s_and_b32 s48, s48, 7
    s_add_u32 m0, s94, 51200
    s_mul_i32 s93, s48, 196608
    buffer_load_dwordx4 v8, s[12:15], s93 offen offset:0  lds
    v_mfma_f32_16x16x32_bf16 v[68:71], v[184:187], v[44:47], v[68:71]
    v_mfma_f32_16x16x32_bf16 v[76:79], v[188:191], v[44:47], v[76:79]
    ds_read_b64_tr_b16 v[34:35], v14 offset:25856
    ds_read_b64_tr_b16 v[36:37], v12 offset:25600
    ds_read_b64_tr_b16 v[38:39], v12 offset:25856
    buffer_load_dwordx4 v8, s[12:15], s93 offen offset:1024  lds
    s_waitcnt lgkmcnt(6)
    v_mfma_f32_16x16x32_bf16 v[48:51], v[24:27], v[184:187], v[48:51]
    v_mfma_f32_16x16x32_bf16 v[52:55], v[24:27], v[188:191], v[52:55]
    ds_read_b64_tr_b16 v[40:41], v14 offset:24576
    ds_read_b64_tr_b16 v[42:43], v14 offset:24832
    ds_read_b64_tr_b16 v[44:45], v12 offset:24576
    s_add_u32 m0, s94, 47104
    s_lshl_b32 s92, s48, 7
    buffer_load_dwordx4 v4, s[8:11], s92 offen offset:0  lds
    v_mfma_f32_16x16x32_bf16 v[56:59], v[28:31], v[184:187], v[56:59]
    v_mfma_f32_16x16x32_bf16 v[60:63], v[28:31], v[188:191], v[60:63]
    ds_read_b64_tr_b16 v[46:47], v12 offset:24832
    buffer_load_dwordx4 v5, s[8:11], s92 offen offset:1024  lds
    s_waitcnt lgkmcnt(4)
    v_mfma_f32_16x16x32_bf16 v[64:67], v[192:195], v[32:35], v[64:67]
    v_mfma_f32_16x16x32_bf16 v[72:75], v[196:199], v[32:35], v[72:75]
    ds_read_b128 v[200:203], v11 offset:24576
    ds_read_b128 v[204:207], v11 offset:26624
    ds_read_b64_tr_b16 v[24:25], v14 offset:37888
    buffer_load_dwordx4 v6, s[8:11], s92 offen offset:2048  lds
    v_mfma_f32_16x16x32_bf16 v[68:71], v[192:195], v[36:39], v[68:71]
    v_mfma_f32_16x16x32_bf16 v[76:79], v[196:199], v[36:39], v[76:79]
    ds_read_b64_tr_b16 v[26:27], v14 offset:38144
    ds_read_b64_tr_b16 v[28:29], v12 offset:37888
    ds_read_b64_tr_b16 v[30:31], v12 offset:38144
    buffer_load_dwordx4 v7, s[8:11], s92 offen offset:3072  lds
    s_waitcnt lgkmcnt(6)
    v_mfma_f32_16x16x32_bf16 v[48:51], v[40:43], v[192:195], v[48:51]
    v_mfma_f32_16x16x32_bf16 v[52:55], v[40:43], v[196:199], v[52:55]
    ds_read_b64_tr_b16 v[32:33], v14 offset:36864
    ds_read_b64_tr_b16 v[34:35], v14 offset:37120
    ds_read_b64_tr_b16 v[36:37], v12 offset:36864
    v_mfma_f32_16x16x32_bf16 v[56:59], v[44:47], v[192:195], v[56:59]
    v_mfma_f32_16x16x32_bf16 v[60:63], v[44:47], v[196:199], v[60:63]
    ds_read_b64_tr_b16 v[38:39], v12 offset:37120
    s_waitcnt lgkmcnt(4)
    v_mfma_f32_16x16x32_bf16 v[64:67], v[200:203], v[24:27], v[64:67]
    v_mfma_f32_16x16x32_bf16 v[72:75], v[204:207], v[24:27], v[72:75]
    s_waitcnt vmcnt(6) lgkmcnt(0)
    s_barrier
    ds_read_b128 v[208:211], v10 offset:49152
    ds_read_b128 v[212:215], v10 offset:51200
    ds_read_b64_tr_b16 v[40:41], v15 offset:1024
    s_add_u32 s48, s7, 7
    s_and_b32 s48, s48, 7
    s_add_u32 m0, s94, 75776
    s_mul_i32 s93, s48, 196608
    buffer_load_dwordx4 v8, s[12:15], s93 offen offset:0  lds
    v_mfma_f32_16x16x32_bf16 v[68:71], v[200:203], v[28:31], v[68:71]
    v_mfma_f32_16x16x32_bf16 v[76:79], v[204:207], v[28:31], v[76:79]
    ds_read_b64_tr_b16 v[42:43], v15 offset:1280
    ds_read_b64_tr_b16 v[44:45], v13 offset:1024
    ds_read_b64_tr_b16 v[46:47], v13 offset:1280
    buffer_load_dwordx4 v8, s[12:15], s93 offen offset:1024  lds
    s_waitcnt lgkmcnt(6)
    v_mfma_f32_16x16x32_bf16 v[48:51], v[32:35], v[200:203], v[48:51]
    v_mfma_f32_16x16x32_bf16 v[52:55], v[32:35], v[204:207], v[52:55]
    ds_read_b64_tr_b16 v[24:25], v15 offset:0
    ds_read_b64_tr_b16 v[26:27], v15 offset:256
    ds_read_b64_tr_b16 v[28:29], v13 offset:0
    s_add_u32 m0, s94, 71680
    s_lshl_b32 s92, s48, 7
    buffer_load_dwordx4 v4, s[8:11], s92 offen offset:0  lds
    v_mfma_f32_16x16x32_bf16 v[56:59], v[36:39], v[200:203], v[56:59]
    v_mfma_f32_16x16x32_bf16 v[60:63], v[36:39], v[204:207], v[60:63]
    ds_read_b64_tr_b16 v[30:31], v13 offset:256
    buffer_load_dwordx4 v5, s[8:11], s92 offen offset:1024  lds
    s_waitcnt lgkmcnt(4)
    v_mfma_f32_16x16x32_bf16 v[64:67], v[208:211], v[40:43], v[64:67]
    v_mfma_f32_16x16x32_bf16 v[72:75], v[212:215], v[40:43], v[72:75]
    ds_read_b128 v[216:219], v11 offset:49152
    ds_read_b128 v[220:223], v11 offset:51200
    ds_read_b64_tr_b16 v[32:33], v15 offset:13312
    buffer_load_dwordx4 v6, s[8:11], s92 offen offset:2048  lds
    v_mfma_f32_16x16x32_bf16 v[68:71], v[208:211], v[44:47], v[68:71]
    v_mfma_f32_16x16x32_bf16 v[76:79], v[212:215], v[44:47], v[76:79]
    ds_read_b64_tr_b16 v[34:35], v15 offset:13568
    ds_read_b64_tr_b16 v[36:37], v13 offset:13312
    ds_read_b64_tr_b16 v[38:39], v13 offset:13568
    buffer_load_dwordx4 v7, s[8:11], s92 offen offset:3072  lds
    s_waitcnt lgkmcnt(6)
    v_mfma_f32_16x16x32_bf16 v[48:51], v[24:27], v[208:211], v[48:51]
    v_mfma_f32_16x16x32_bf16 v[52:55], v[24:27], v[212:215], v[52:55]
    ds_read_b64_tr_b16 v[40:41], v15 offset:12288
    ds_read_b64_tr_b16 v[42:43], v15 offset:12544
    ds_read_b64_tr_b16 v[44:45], v13 offset:12288
    v_mfma_f32_16x16x32_bf16 v[56:59], v[28:31], v[208:211], v[56:59]
    v_mfma_f32_16x16x32_bf16 v[60:63], v[28:31], v[212:215], v[60:63]
    ds_read_b64_tr_b16 v[46:47], v13 offset:12544
    s_waitcnt lgkmcnt(4)
    v_mfma_f32_16x16x32_bf16 v[64:67], v[216:219], v[32:35], v[64:67]
    v_mfma_f32_16x16x32_bf16 v[72:75], v[220:223], v[32:35], v[72:75]
    s_waitcnt vmcnt(6) lgkmcnt(0)
    s_barrier
    ds_read_b128 v[224:227], v10 offset:0
    ds_read_b128 v[228:231], v10 offset:2048
    ds_read_b64_tr_b16 v[24:25], v14 offset:1024
    s_add_u32 s49, s7, 0
    s_and_b32 s49, s49, 7
    s_add_u32 m0, s27, 120832
    s_mul_i32 s49, s49, 196608
    buffer_load_dwordx4 v9, s[12:15], s49 offen lds
    v_mfma_f32_16x16x32_bf16 v[68:71], v[216:219], v[36:39], v[68:71]
    v_mfma_f32_16x16x32_bf16 v[76:79], v[220:223], v[36:39], v[76:79]
    ds_read_b64_tr_b16 v[26:27], v14 offset:1280
    ds_read_b64_tr_b16 v[28:29], v12 offset:1024
    ds_read_b64_tr_b16 v[30:31], v12 offset:1280
    s_add_u32 s49, s7, 1
    s_and_b32 s49, s49, 7
    s_add_u32 m0, s27, 124928
    s_mul_i32 s49, s49, 196608
    buffer_load_dwordx4 v9, s[12:15], s49 offen lds
    s_waitcnt lgkmcnt(6)
    v_mfma_f32_16x16x32_bf16 v[48:51], v[40:43], v[216:219], v[48:51]
    v_mfma_f32_16x16x32_bf16 v[52:55], v[40:43], v[220:223], v[52:55]
    ds_read_b64_tr_b16 v[32:33], v14 offset:0
    ds_read_b64_tr_b16 v[34:35], v14 offset:256
    ds_read_b64_tr_b16 v[36:37], v12 offset:0
    s_add_u32 s49, s7, 2
    s_and_b32 s49, s49, 7
    s_add_u32 m0, s27, 129024
    s_mul_i32 s49, s49, 196608
    buffer_load_dwordx4 v9, s[12:15], s49 offen lds
    v_mfma_f32_16x16x32_bf16 v[56:59], v[44:47], v[216:219], v[56:59]
    v_mfma_f32_16x16x32_bf16 v[60:63], v[44:47], v[220:223], v[60:63]
    ds_read_b64_tr_b16 v[38:39], v12 offset:256
    s_add_u32 s49, s7, 3
    s_and_b32 s49, s49, 7
    s_add_u32 m0, s27, 133120
    s_mul_i32 s49, s49, 196608
    buffer_load_dwordx4 v9, s[12:15], s49 offen lds
    s_waitcnt lgkmcnt(4)
    v_mfma_f32_16x16x32_bf16 v[64:67], v[224:227], v[24:27], v[64:67]
    v_mfma_f32_16x16x32_bf16 v[72:75], v[228:231], v[24:27], v[72:75]
    ds_read_b128 v[232:235], v11 offset:0
    ds_read_b128 v[236:239], v11 offset:2048
    ds_read_b64_tr_b16 v[40:41], v14 offset:13312
    v_mfma_f32_16x16x32_bf16 v[68:71], v[224:227], v[28:31], v[68:71]
    v_mfma_f32_16x16x32_bf16 v[76:79], v[228:231], v[28:31], v[76:79]
    ds_read_b64_tr_b16 v[42:43], v14 offset:13568
    ds_read_b64_tr_b16 v[44:45], v12 offset:13312
    ds_read_b64_tr_b16 v[46:47], v12 offset:13568
    s_waitcnt lgkmcnt(6)
    v_mfma_f32_16x16x32_bf16 v[48:51], v[32:35], v[224:227], v[48:51]
    v_mfma_f32_16x16x32_bf16 v[52:55], v[32:35], v[228:231], v[52:55]
    ds_read_b64_tr_b16 v[24:25], v14 offset:12288
    ds_read_b64_tr_b16 v[26:27], v14 offset:12544
    ds_read_b64_tr_b16 v[28:29], v12 offset:12288
    v_mfma_f32_16x16x32_bf16 v[56:59], v[36:39], v[224:227], v[56:59]
    v_mfma_f32_16x16x32_bf16 v[60:63], v[36:39], v[228:231], v[60:63]
    ds_read_b64_tr_b16 v[30:31], v12 offset:12544
    s_waitcnt lgkmcnt(4)
    v_mfma_f32_16x16x32_bf16 v[64:67], v[232:235], v[40:43], v[64:67]
    v_mfma_f32_16x16x32_bf16 v[72:75], v[236:239], v[40:43], v[72:75]
    s_waitcnt vmcnt(4) lgkmcnt(0)
    s_barrier
    ds_read_b128 v[240:243], v10 offset:24576
    ds_read_b128 v[244:247], v10 offset:26624
    ds_read_b64_tr_b16 v[32:33], v14 offset:25600
    s_add_u32 s49, s7, 4
    s_and_b32 s49, s49, 7
    s_add_u32 m0, s27, 137216
    s_mul_i32 s49, s49, 196608
    buffer_load_dwordx4 v9, s[12:15], s49 offen lds
    v_mfma_f32_16x16x32_bf16 v[68:71], v[232:235], v[44:47], v[68:71]
    v_mfma_f32_16x16x32_bf16 v[76:79], v[236:239], v[44:47], v[76:79]
    ds_read_b64_tr_b16 v[34:35], v14 offset:25856
    ds_read_b64_tr_b16 v[36:37], v12 offset:25600
    ds_read_b64_tr_b16 v[38:39], v12 offset:25856
    s_add_u32 s49, s7, 5
    s_and_b32 s49, s49, 7
    s_add_u32 m0, s27, 141312
    s_mul_i32 s49, s49, 196608
    buffer_load_dwordx4 v9, s[12:15], s49 offen lds
    s_waitcnt lgkmcnt(6)
    v_mfma_f32_16x16x32_bf16 v[48:51], v[24:27], v[232:235], v[48:51]
    v_mfma_f32_16x16x32_bf16 v[52:55], v[24:27], v[236:239], v[52:55]
    ds_read_b64_tr_b16 v[40:41], v14 offset:24576
    ds_read_b64_tr_b16 v[42:43], v14 offset:24832
    ds_read_b64_tr_b16 v[44:45], v12 offset:24576
    s_add_u32 s49, s7, 6
    s_and_b32 s49, s49, 7
    s_add_u32 m0, s27, 145408
    s_mul_i32 s49, s49, 196608
    buffer_load_dwordx4 v9, s[12:15], s49 offen lds
    v_mfma_f32_16x16x32_bf16 v[56:59], v[28:31], v[232:235], v[56:59]
    v_mfma_f32_16x16x32_bf16 v[60:63], v[28:31], v[236:239], v[60:63]
    ds_read_b64_tr_b16 v[46:47], v12 offset:24832
    s_add_u32 s49, s7, 7
    s_and_b32 s49, s49, 7
    s_add_u32 m0, s27, 149504
    s_mul_i32 s49, s49, 196608
    buffer_load_dwordx4 v9, s[12:15], s49 offen lds
    s_waitcnt lgkmcnt(4)
    v_mfma_f32_16x16x32_bf16 v[64:67], v[240:243], v[32:35], v[64:67]
    v_mfma_f32_16x16x32_bf16 v[72:75], v[244:247], v[32:35], v[72:75]
    ds_read_b128 v[248:251], v11 offset:24576
    ds_read_b128 v[252:255], v11 offset:26624
    ds_read_b64_tr_b16 v[24:25], v14 offset:37888
    v_mfma_f32_16x16x32_bf16 v[68:71], v[240:243], v[36:39], v[68:71]
    v_mfma_f32_16x16x32_bf16 v[76:79], v[244:247], v[36:39], v[76:79]
    ds_read_b64_tr_b16 v[26:27], v14 offset:38144
    ds_read_b64_tr_b16 v[28:29], v12 offset:37888
    ds_read_b64_tr_b16 v[30:31], v12 offset:38144
    s_waitcnt lgkmcnt(6)
    v_mfma_f32_16x16x32_bf16 v[48:51], v[40:43], v[240:243], v[48:51]
    v_mfma_f32_16x16x32_bf16 v[52:55], v[40:43], v[244:247], v[52:55]
    ds_read_b64_tr_b16 v[32:33], v14 offset:36864
    ds_read_b64_tr_b16 v[34:35], v14 offset:37120
    ds_read_b64_tr_b16 v[36:37], v12 offset:36864
    v_mfma_f32_16x16x32_bf16 v[56:59], v[44:47], v[240:243], v[56:59]
    v_mfma_f32_16x16x32_bf16 v[60:63], v[44:47], v[244:247], v[60:63]
    ds_read_b64_tr_b16 v[38:39], v12 offset:37120
    s_waitcnt lgkmcnt(4)
    v_mfma_f32_16x16x32_bf16 v[64:67], v[248:251], v[24:27], v[64:67]
    v_mfma_f32_16x16x32_bf16 v[72:75], v[252:255], v[24:27], v[72:75]
    v_mfma_f32_16x16x32_bf16 v[68:71], v[248:251], v[28:31], v[68:71]
    v_mfma_f32_16x16x32_bf16 v[76:79], v[252:255], v[28:31], v[76:79]
    s_waitcnt lgkmcnt(0)
    v_mfma_f32_16x16x32_bf16 v[48:51], v[32:35], v[248:251], v[48:51]
    v_mfma_f32_16x16x32_bf16 v[52:55], v[32:35], v[252:255], v[52:55]
    v_mfma_f32_16x16x32_bf16 v[56:59], v[36:39], v[248:251], v[56:59]
    v_mfma_f32_16x16x32_bf16 v[60:63], v[36:39], v[252:255], v[60:63]
    s_nop 2
    v_cvt_pk_bf16_f32 v104, v64, v65
    v_cvt_pk_bf16_f32 v105, v66, v67
    v_cvt_pk_bf16_f32 v106, v68, v69
    v_cvt_pk_bf16_f32 v107, v70, v71
    v_cvt_pk_bf16_f32 v108, v72, v73
    v_cvt_pk_bf16_f32 v109, v74, v75
    v_cvt_pk_bf16_f32 v110, v76, v77
    v_cvt_pk_bf16_f32 v111, v78, v79
    v_cvt_pk_bf16_f32 v96, v48, v49
    v_cvt_pk_bf16_f32 v97, v50, v51
    v_cvt_pk_bf16_f32 v98, v52, v53
    v_cvt_pk_bf16_f32 v99, v54, v55
    v_permlane16_swap_b32 v104, v106
    v_permlane16_swap_b32 v105, v107
    global_store_dwordx4 v117, v[104:107], s[46:47] offset:1024 sc1
    v_cvt_pk_bf16_f32 v100, v56, v57
    v_cvt_pk_bf16_f32 v101, v58, v59
    v_cvt_pk_bf16_f32 v102, v60, v61
    v_cvt_pk_bf16_f32 v103, v62, v63
    v_permlane16_swap_b32 v108, v110
    v_permlane16_swap_b32 v109, v111
    global_store_dwordx4 v117, v[108:111], s[46:47] offset:1536 sc1
    v_permlane16_swap_b32 v96, v98
    v_permlane16_swap_b32 v97, v99
    global_store_dwordx4 v115, v[96:99], s[46:47] sc1
    v_permlane16_swap_b32 v100, v102
    v_permlane16_swap_b32 v101, v103
    global_store_dwordx4 v116, v[100:103], s[46:47] sc1
    s_waitcnt vmcnt(8)
    s_barrier
    ds_read_b64_tr_b16 v[40:41], v16 offset:0
    ds_read_b64_tr_b16 v[42:43], v16 offset:256
    ds_read_b64_tr_b16 v[44:45], v23 offset:0
    ds_read_b64_tr_b16 v[46:47], v23 offset:256
    ds_read_b64_tr_b16 v[24:25], v16 offset:2048
    ds_read_b64_tr_b16 v[26:27], v16 offset:2304
    ds_read_b64_tr_b16 v[28:29], v23 offset:2048
    ds_read_b64_tr_b16 v[30:31], v23 offset:2304
    ds_read_b64_tr_b16 v[32:33], v16 offset:4096
    ds_read_b64_tr_b16 v[34:35], v16 offset:4352
    ds_read_b64_tr_b16 v[36:37], v23 offset:4096
    ds_read_b64_tr_b16 v[38:39], v23 offset:4352
    ds_read_b64_tr_b16 v[64:65], v16 offset:6144
    ds_read_b64_tr_b16 v[66:67], v16 offset:6400
    s_waitcnt lgkmcnt(12)
    v_mfma_f32_16x16x32_bf16 v[80:83], v[40:43], v[128:131], 0
    v_mfma_f32_16x16x32_bf16 v[84:87], v[40:43], v[132:135], 0
    ds_read_b64_tr_b16 v[68:69], v23 offset:6144
    ds_read_b64_tr_b16 v[70:71], v23 offset:6400
    s_waitcnt lgkmcnt(12)
    v_mfma_f32_16x16x32_bf16 v[88:91], v[44:47], v[128:131], 0
    v_mfma_f32_16x16x32_bf16 v[92:95], v[44:47], v[132:135], 0
    ds_read_b64_tr_b16 v[72:73], v16 offset:8192
    ds_read_b64_tr_b16 v[74:75], v16 offset:8448
    s_waitcnt lgkmcnt(12)
    v_mfma_f32_16x16x32_bf16 v[80:83], v[24:27], v[136:139], v[80:83]
    v_mfma_f32_16x16x32_bf16 v[84:87], v[24:27], v[140:143], v[84:87]
    ds_read_b64_tr_b16 v[40:41], v23 offset:8192
    ds_read_b64_tr_b16 v[42:43], v23 offset:8448
    v_mov_b32 v128, 0
    v_mov_b32 v129, 0
    v_mov_b32 v130, 0
    v_mov_b32 v131, 0
    s_waitcnt lgkmcnt(12)
    v_mfma_f32_16x16x32_bf16 v[88:91], v[28:31], v[136:139], v[88:91]
    v_mfma_f32_16x16x32_bf16 v[92:95], v[28:31], v[140:143], v[92:95]
    ds_read_b64_tr_b16 v[44:45], v16 offset:10240
    ds_read_b64_tr_b16 v[46:47], v16 offset:10496
    v_mov_b32 v132, 0
    v_mov_b32 v133, 0
    v_mov_b32 v134, 0
    v_mov_b32 v135, 0
    s_waitcnt lgkmcnt(12)
    v_mfma_f32_16x16x32_bf16 v[80:83], v[32:35], v[144:147], v[80:83]
    v_mfma_f32_16x16x32_bf16 v[84:87], v[32:35], v[148:151], v[84:87]
    ds_read_b64_tr_b16 v[24:25], v23 offset:10240
    ds_read_b64_tr_b16 v[26:27], v23 offset:10496
    s_waitcnt lgkmcnt(12)
    v_mfma_f32_16x16x32_bf16 v[88:91], v[36:39], v[144:147], v[88:91]
    v_mfma_f32_16x16x32_bf16 v[92:95], v[36:39], v[148:151], v[92:95]
    ds_read_b64_tr_b16 v[28:29], v16 offset:12288
    ds_read_b64_tr_b16 v[30:31], v16 offset:12544
    s_waitcnt lgkmcnt(12)
    v_mfma_f32_16x16x32_bf16 v[80:83], v[64:67], v[152:155], v[80:83]
    v_mfma_f32_16x16x32_bf16 v[84:87], v[64:67], v[156:159], v[84:87]
    ds_read_b64_tr_b16 v[32:33], v23 offset:12288
    ds_read_b64_tr_b16 v[34:35], v23 offset:12544
    v_mov_b32 v144, 0
    v_mov_b32 v145, 0
    v_mov_b32 v146, 0
    v_mov_b32 v147, 0
    s_waitcnt lgkmcnt(12)
    v_mfma_f32_16x16x32_bf16 v[88:91], v[68:71], v[152:155], v[88:91]
    v_mfma_f32_16x16x32_bf16 v[92:95], v[68:71], v[156:159], v[92:95]
    ds_read_b64_tr_b16 v[36:37], v16 offset:14336
    ds_read_b64_tr_b16 v[38:39], v16 offset:14592
    v_mov_b32 v148, 0
    v_mov_b32 v149, 0
    v_mov_b32 v150, 0
    v_mov_b32 v151, 0
    s_waitcnt lgkmcnt(12)
    v_mfma_f32_16x16x32_bf16 v[80:83], v[72:75], v[160:163], v[80:83]
    v_mfma_f32_16x16x32_bf16 v[84:87], v[72:75], v[164:167], v[84:87]
    ds_read_b64_tr_b16 v[64:65], v23 offset:14336
    ds_read_b64_tr_b16 v[66:67], v23 offset:14592
    s_waitcnt lgkmcnt(12)
    v_mfma_f32_16x16x32_bf16 v[88:91], v[40:43], v[160:163], v[88:91]
    v_mfma_f32_16x16x32_bf16 v[92:95], v[40:43], v[164:167], v[92:95]
    s_waitcnt vmcnt(4)
    s_barrier
    ds_read_b64_tr_b16 v[68:69], v16 offset:16384
    ds_read_b64_tr_b16 v[70:71], v16 offset:16640
    s_waitcnt lgkmcnt(12)
    v_mfma_f32_16x16x32_bf16 v[80:83], v[44:47], v[168:171], v[80:83]
    v_mfma_f32_16x16x32_bf16 v[84:87], v[44:47], v[172:175], v[84:87]
    ds_read_b64_tr_b16 v[72:73], v23 offset:16384
    ds_read_b64_tr_b16 v[74:75], v23 offset:16640
    v_mov_b32 v160, 0
    v_mov_b32 v161, 0
    v_mov_b32 v162, 0
    v_mov_b32 v163, 0
    s_waitcnt lgkmcnt(12)
    v_mfma_f32_16x16x32_bf16 v[88:91], v[24:27], v[168:171], v[88:91]
    v_mfma_f32_16x16x32_bf16 v[92:95], v[24:27], v[172:175], v[92:95]
    ds_read_b64_tr_b16 v[40:41], v16 offset:18432
    ds_read_b64_tr_b16 v[42:43], v16 offset:18688
    v_mov_b32 v164, 0
    v_mov_b32 v165, 0
    v_mov_b32 v166, 0
    v_mov_b32 v167, 0
    s_waitcnt lgkmcnt(12)
    v_mfma_f32_16x16x32_bf16 v[80:83], v[28:31], v[176:179], v[80:83]
    v_mfma_f32_16x16x32_bf16 v[84:87], v[28:31], v[180:183], v[84:87]
    ds_read_b64_tr_b16 v[44:45], v23 offset:18432
    ds_read_b64_tr_b16 v[46:47], v23 offset:18688
    s_waitcnt lgkmcnt(12)
    v_mfma_f32_16x16x32_bf16 v[88:91], v[32:35], v[176:179], v[88:91]
    v_mfma_f32_16x16x32_bf16 v[92:95], v[32:35], v[180:183], v[92:95]
    ds_read_b64_tr_b16 v[24:25], v16 offset:20480
    ds_read_b64_tr_b16 v[26:27], v16 offset:20736
    s_waitcnt lgkmcnt(12)
    v_mfma_f32_16x16x32_bf16 v[80:83], v[36:39], v[184:187], v[80:83]
    v_mfma_f32_16x16x32_bf16 v[84:87], v[36:39], v[188:191], v[84:87]
    ds_read_b64_tr_b16 v[28:29], v23 offset:20480
    ds_read_b64_tr_b16 v[30:31], v23 offset:20736
    v_mov_b32 v176, 0
    v_mov_b32 v177, 0
    v_mov_b32 v178, 0
    v_mov_b32 v179, 0
    s_waitcnt lgkmcnt(12)
    v_mfma_f32_16x16x32_bf16 v[88:91], v[64:67], v[184:187], v[88:91]
    v_mfma_f32_16x16x32_bf16 v[92:95], v[64:67], v[188:191], v[92:95]
    ds_read_b64_tr_b16 v[32:33], v16 offset:22528
    ds_read_b64_tr_b16 v[34:35], v16 offset:22784
    v_mov_b32 v180, 0
    v_mov_b32 v181, 0
    v_mov_b32 v182, 0
    v_mov_b32 v183, 0
    s_waitcnt lgkmcnt(12)
    v_mfma_f32_16x16x32_bf16 v[80:83], v[68:71], v[192:195], v[80:83]
    v_mfma_f32_16x16x32_bf16 v[84:87], v[68:71], v[196:199], v[84:87]
    ds_read_b64_tr_b16 v[36:37], v23 offset:22528
    ds_read_b64_tr_b16 v[38:39], v23 offset:22784
    s_waitcnt lgkmcnt(12)
    v_mfma_f32_16x16x32_bf16 v[88:91], v[72:75], v[192:195], v[88:91]
    v_mfma_f32_16x16x32_bf16 v[92:95], v[72:75], v[196:199], v[92:95]
    ds_read_b64_tr_b16 v[64:65], v16 offset:24576
    ds_read_b64_tr_b16 v[66:67], v16 offset:24832
    s_waitcnt lgkmcnt(12)
    v_mfma_f32_16x16x32_bf16 v[80:83], v[40:43], v[200:203], v[80:83]
    v_mfma_f32_16x16x32_bf16 v[84:87], v[40:43], v[204:207], v[84:87]
    ds_read_b64_tr_b16 v[68:69], v23 offset:24576
    ds_read_b64_tr_b16 v[70:71], v23 offset:24832
    s_waitcnt lgkmcnt(12)
    v_mfma_f32_16x16x32_bf16 v[88:91], v[44:47], v[200:203], v[88:91]
    v_mfma_f32_16x16x32_bf16 v[92:95], v[44:47], v[204:207], v[92:95]
    ds_read_b64_tr_b16 v[72:73], v16 offset:26624
    ds_read_b64_tr_b16 v[74:75], v16 offset:26880
    s_waitcnt lgkmcnt(12)
    v_mfma_f32_16x16x32_bf16 v[80:83], v[24:27], v[208:211], v[80:83]
    v_mfma_f32_16x16x32_bf16 v[84:87], v[24:27], v[212:215], v[84:87]
    ds_read_b64_tr_b16 v[40:41], v23 offset:26624
    ds_read_b64_tr_b16 v[42:43], v23 offset:26880
    s_waitcnt lgkmcnt(12)
    v_mfma_f32_16x16x32_bf16 v[88:91], v[28:31], v[208:211], v[88:91]
    v_mfma_f32_16x16x32_bf16 v[92:95], v[28:31], v[212:215], v[92:95]
    ds_read_b64_tr_b16 v[44:45], v16 offset:28672
    ds_read_b64_tr_b16 v[46:47], v16 offset:28928
    s_waitcnt lgkmcnt(12)
    v_mfma_f32_16x16x32_bf16 v[80:83], v[32:35], v[216:219], v[80:83]
    v_mfma_f32_16x16x32_bf16 v[84:87], v[32:35], v[220:223], v[84:87]
    s_waitcnt vmcnt(0)
    s_barrier
    ds_read_b64_tr_b16 v[24:25], v23 offset:28672
    ds_read_b64_tr_b16 v[26:27], v23 offset:28928
    s_waitcnt lgkmcnt(12)
    v_mfma_f32_16x16x32_bf16 v[88:91], v[36:39], v[216:219], v[88:91]
    v_mfma_f32_16x16x32_bf16 v[92:95], v[36:39], v[220:223], v[92:95]
    ds_read_b64_tr_b16 v[28:29], v16 offset:30720
    ds_read_b64_tr_b16 v[30:31], v16 offset:30976
    s_waitcnt lgkmcnt(12)
    v_mfma_f32_16x16x32_bf16 v[80:83], v[64:67], v[224:227], v[80:83]
    v_mfma_f32_16x16x32_bf16 v[84:87], v[64:67], v[228:231], v[84:87]
    ds_read_b64_tr_b16 v[32:33], v23 offset:30720
    ds_read_b64_tr_b16 v[34:35], v23 offset:30976
    s_waitcnt lgkmcnt(12)
    v_mfma_f32_16x16x32_bf16 v[88:91], v[68:71], v[224:227], v[88:91]
    v_mfma_f32_16x16x32_bf16 v[92:95], v[68:71], v[228:231], v[92:95]
    ds_read_b128 v[136:139], v22
    ds_read_b128 v[140:143], v22
    s_waitcnt lgkmcnt(12)
    v_mfma_f32_16x16x32_bf16 v[80:83], v[72:75], v[232:235], v[80:83]
    v_mfma_f32_16x16x32_bf16 v[84:87], v[72:75], v[236:239], v[84:87]
    ds_read_b128 v[152:155], v22
    ds_read_b128 v[156:159], v22
    s_waitcnt lgkmcnt(12)
    v_mfma_f32_16x16x32_bf16 v[88:91], v[40:43], v[232:235], v[88:91]
    v_mfma_f32_16x16x32_bf16 v[92:95], v[40:43], v[236:239], v[92:95]
    ds_read_b128 v[168:171], v22
    ds_read_b128 v[172:175], v22
    s_waitcnt lgkmcnt(12)
    v_mfma_f32_16x16x32_bf16 v[80:83], v[44:47], v[240:243], v[80:83]
    v_mfma_f32_16x16x32_bf16 v[84:87], v[44:47], v[244:247], v[84:87]
    ds_read_b128 v[184:187], v22
    ds_read_b128 v[188:191], v22
    s_waitcnt lgkmcnt(12)
    v_mfma_f32_16x16x32_bf16 v[88:91], v[24:27], v[240:243], v[88:91]
    v_mfma_f32_16x16x32_bf16 v[92:95], v[24:27], v[244:247], v[92:95]
    ds_write_b128 v118, v[96:99] offset:2048
    ds_write_b128 v118, v[100:103] offset:3072
    s_waitcnt lgkmcnt(12)
    v_mfma_f32_16x16x32_bf16 v[80:83], v[28:31], v[248:251], v[80:83]
    v_mfma_f32_16x16x32_bf16 v[84:87], v[28:31], v[252:255], v[84:87]
    ds_write_b128 v118, v[104:107] offset:4096
    ds_write_b128 v118, v[108:111] offset:5120
    s_waitcnt lgkmcnt(12)
    v_mfma_f32_16x16x32_bf16 v[88:91], v[32:35], v[248:251], v[88:91]
    v_mfma_f32_16x16x32_bf16 v[92:95], v[32:35], v[252:255], v[92:95]
    ds_read_b128 v[196:199], v21
    ds_read_b128 v[200:203], v21
    ds_read_b128 v[208:211], v21
    ds_read_b128 v[212:215], v21
    ds_read_b128 v[220:223], v21
    ds_read_b128 v[224:227], v21
    ds_read_b128 v[232:235], v21
    ds_read_b128 v[236:239], v21
    v_mul_f32 v80, s101, v80
    v_mul_f32 v81, s101, v81
    v_mul_f32 v82, s101, v82
    v_mul_f32 v83, s101, v83
    v_mul_f32 v84, s101, v84
    v_mul_f32 v85, s101, v85
    v_mul_f32 v86, s101, v86
    v_mul_f32 v87, s101, v87
    v_cvt_pk_bf16_f32 v48, v80, v81
    v_cvt_pk_bf16_f32 v50, v84, v85
    v_cvt_pk_bf16_f32 v49, v82, v83
    v_cvt_pk_bf16_f32 v51, v86, v87
    v_permlane16_swap_b32 v48, v50
    s_nop 0
    v_permlane16_swap_b32 v49, v51
    ds_write_b128 v118, v[48:51] offset:0
    v_mul_f32 v88, s101, v88
    v_mul_f32 v89, s101, v89
    v_mul_f32 v90, s101, v90
    v_mul_f32 v91, s101, v91
    v_mul_f32 v92, s101, v92
    v_mul_f32 v93, s101, v93
    v_mul_f32 v94, s101, v94
    v_mul_f32 v95, s101, v95
    v_cvt_pk_bf16_f32 v52, v88, v89
    v_cvt_pk_bf16_f32 v54, v92, v93
    v_cvt_pk_bf16_f32 v53, v90, v91
    v_cvt_pk_bf16_f32 v55, v94, v95
    v_permlane16_swap_b32 v52, v54
    s_nop 0
    v_permlane16_swap_b32 v53, v55
    ds_write_b128 v118, v[52:55] offset:1024
    s_waitcnt lgkmcnt(0)
    s_barrier
    ds_read_b128 v[240:243], v120
    ds_read_b128 v[192:195], v119 offset:2048
    ds_read_b128 v[244:247], v120 offset:6144
    s_mov_b64 exec, s[56:57]
    ds_read_b128 v[196:199], v121 offset:4096
    ds_read_b128 v[200:203], v121 offset:5120
    ds_read_b128 v[208:211], v121 offset:10240
    ds_read_b128 v[212:215], v121 offset:11264
    s_mov_b64 exec, -1
    ds_read_b128 v[248:251], v119
    ds_read_b128 v[252:255], v119 offset:6144
    ds_read_b128 v[204:207], v119 offset:8192
    s_waitcnt lgkmcnt(8)
    v_mfma_f32_32x32x16_bf16 v[24:39], v[192:195], v[240:243], 0
    v_mov_b32 v6, 0
    v_mov_b32 v4, 0
    v_mov_b32 v5, s26
    v_mov_b32 v2, s3
    s_lshl_b32 s92, s3, 13
    s_add_u32 m0, s92, 47104
    s_nop 4
    s_waitcnt lgkmcnt(0)
    v_exp_f32 v24, v24
    v_exp_f32 v25, v25
    v_exp_f32 v26, v26
    v_exp_f32 v27, v27
    v_exp_f32 v28, v28
    v_mfma_f32_32x32x16_bf16 v[40:55], v[192:195], v[244:247], 0
    v_exp_f32 v29, v29
    v_exp_f32 v30, v30
    v_exp_f32 v31, v31
    v_exp_f32 v32, v32
    v_exp_f32 v33, v33
    v_exp_f32 v34, v34
    v_smfmac_f32_32x32x32_bf16 v[128:143], v[196:199], v[24:31], v112
    v_exp_f32 v35, v35
    v_exp_f32 v36, v36
    v_exp_f32 v37, v37
    v_exp_f32 v38, v38
    v_exp_f32 v39, v39
    v_exp_f32 v40, v40
    v_exp_f32 v41, v41
    v_smfmac_f32_32x32x32_bf16 v[128:143], v[200:203], v[32:39], v112
    v_exp_f32 v42, v42
    v_exp_f32 v43, v43
    v_exp_f32 v44, v44
    v_mfma_f32_32x32x16_bf16 v[24:39], v[192:195], v[248:251], 0
    v_exp_f32 v45, v45
    v_exp_f32 v46, v46
    v_exp_f32 v47, v47
    v_exp_f32 v48, v48
    v_exp_f32 v49, v49
    v_exp_f32 v50, v50
    v_smfmac_f32_32x32x32_bf16 v[144:159], v[196:199], v[40:47], v112
    s_barrier
    global_load_dwordx4 v[216:219], v113, s[52:53] offset:0 sc1
    s_mov_b64 exec, s[56:57]
    global_load_dwordx4 v[220:223], v114, s[52:53] offset:1024 sc1
    global_load_dwordx4 v[224:227], v114, s[52:53] offset:1536 sc1
    global_load_dwordx4 v[232:235], v114, s[52:53] offset:3072 sc1
    global_load_dwordx4 v[236:239], v114, s[52:53] offset:3584 sc1
    s_mov_b64 exec, -1
    global_load_dwordx4 v[228:231], v113, s[52:53] offset:2048 sc1
    s_add_u32 s54, s54, 1
    s_cmp_eq_u32 s54, s28
    s_addc_u32 s54, s54, 0
    s_lshl_b32 s29, s54, 13
    s_and_b32 s29, s29, 0x1e000
    s_add_u32 s52, s50, s29
    s_addc_u32 s53, s51, 0
    v_exp_f32 v51, v51
    v_exp_f32 v52, v52
    v_exp_f32 v53, v53
    v_exp_f32 v54, v54
    v_exp_f32 v55, v55
    v_exp_f32 v24, v24
    v_exp_f32 v25, v25
    v_smfmac_f32_32x32x32_bf16 v[144:159], v[200:203], v[48:55], v112
    v_exp_f32 v26, v26
    v_exp_f32 v27, v27
    v_exp_f32 v28, v28
    v_mfma_f32_32x32x16_bf16 v[40:55], v[192:195], v[252:255], 0
    v_exp_f32 v29, v29
    v_exp_f32 v30, v30
    v_exp_f32 v31, v31
    v_exp_f32 v32, v32
    v_exp_f32 v33, v33
    v_exp_f32 v34, v34
    v_smfmac_f32_32x32x32_bf16 v[160:175], v[196:199], v[24:31], v112
    v_exp_f32 v35, v35
    v_exp_f32 v36, v36
    v_exp_f32 v37, v37
    v_exp_f32 v38, v38
    v_exp_f32 v39, v39
    v_exp_f32 v40, v40
    v_exp_f32 v41, v41
    v_smfmac_f32_32x32x32_bf16 v[160:175], v[200:203], v[32:39], v112
    v_exp_f32 v42, v42
    v_exp_f32 v43, v43
    v_exp_f32 v44, v44
    v_mfma_f32_32x32x16_bf16 v[24:39], v[204:207], v[240:243], 0
    v_exp_f32 v45, v45
    v_exp_f32 v46, v46
    v_exp_f32 v47, v47
    v_exp_f32 v48, v48
    v_exp_f32 v49, v49
    v_exp_f32 v50, v50
    v_smfmac_f32_32x32x32_bf16 v[176:191], v[196:199], v[40:47], v112
    .p2align 3
L_attn:
    v_exp_f32 v51, v51
    v_exp_f32 v52, v52
    v_exp_f32 v53, v53
    v_exp_f32 v54, v54
    v_exp_f32 v55, v55
    v_exp_f32 v24, v24
    v_exp_f32 v25, v25
    v_smfmac_f32_32x32x32_bf16 v[176:191], v[200:203], v[48:55], v112
    s_mov_b64 exec, s[56:57]
    global_load_dwordx4 v[196:199], v114, s[52:53] offset:1024 sc1
    global_load_dwordx4 v[200:203], v114, s[52:53] offset:1536 sc1
    s_mov_b64 exec, -1
    v_exp_f32 v26, v26
    v_exp_f32 v27, v27
    v_exp_f32 v28, v28
    v_mfma_f32_32x32x16_bf16 v[40:55], v[204:207], v[244:247], 0
    global_load_dwordx4 v[192:195], v113, s[52:53] offset:0 sc1
    v_exp_f32 v29, v29
    v_exp_f32 v30, v30
    v_exp_f32 v31, v31
    v_exp_f32 v32, v32
    v_exp_f32 v33, v33
    v_exp_f32 v34, v34
    v_smfmac_f32_32x32x32_bf16 v[128:143], v[208:211], v[24:31], v112
    v_exp_f32 v35, v35
    v_exp_f32 v36, v36
    v_exp_f32 v37, v37
    v_exp_f32 v38, v38
    v_exp_f32 v39, v39
    v_exp_f32 v40, v40
    v_exp_f32 v41, v41
    v_smfmac_f32_32x32x32_bf16 v[128:143], v[212:215], v[32:39], v112
    v_exp_f32 v42, v42
    v_exp_f32 v43, v43
    v_exp_f32 v44, v44
    v_mfma_f32_32x32x16_bf16 v[24:39], v[204:207], v[248:251], 0
    v_exp_f32 v45, v45
    v_exp_f32 v46, v46
    v_exp_f32 v47, v47
    v_exp_f32 v48, v48
    v_exp_f32 v49, v49
    v_exp_f32 v50, v50
    v_smfmac_f32_32x32x32_bf16 v[144:159], v[208:211], v[40:47], v112
    v_exp_f32 v51, v51
    v_exp_f32 v52, v52
    v_exp_f32 v53, v53
    v_exp_f32 v54, v54
    v_exp_f32 v55, v55
    v_exp_f32 v24, v24
    v_exp_f32 v25, v25
    v_smfmac_f32_32x32x32_bf16 v[144:159], v[212:215], v[48:55], v112
    v_exp_f32 v26, v26
    v_exp_f32 v27, v27
    v_exp_f32 v28, v28
    v_mfma_f32_32x32x16_bf16 v[40:55], v[204:207], v[252:255], 0
    v_exp_f32 v29, v29
    v_exp_f32 v30, v30
    v_exp_f32 v31, v31
    v_exp_f32 v32, v32
    v_exp_f32 v33, v33
    v_exp_f32 v34, v34
    v_smfmac_f32_32x32x32_bf16 v[160:175], v[208:211], v[24:31], v112
    v_exp_f32 v35, v35
    v_exp_f32 v36, v36
    v_exp_f32 v37, v37
    v_exp_f32 v38, v38
    v_exp_f32 v39, v39
    v_exp_f32 v40, v40
    v_exp_f32 v41, v41
    v_smfmac_f32_32x32x32_bf16 v[160:175], v[212:215], v[32:39], v112
    s_waitcnt vmcnt(6)
    v_exp_f32 v42, v42
    v_exp_f32 v43, v43
    v_exp_f32 v44, v44
    v_mfma_f32_32x32x16_bf16 v[24:39], v[216:219], v[240:243], 0
    v_exp_f32 v45, v45
    v_exp_f32 v46, v46
    v_exp_f32 v47, v47
    v_exp_f32 v48, v48
    v_exp_f32 v49, v49
    v_exp_f32 v50, v50
    v_smfmac_f32_32x32x32_bf16 v[176:191], v[208:211], v[40:47], v112
    v_exp_f32 v51, v51
    v_exp_f32 v52, v52
    v_exp_f32 v53, v53
    v_exp_f32 v54, v54
    v_exp_f32 v55, v55
    v_exp_f32 v24, v24
    v_exp_f32 v25, v25
    v_smfmac_f32_32x32x32_bf16 v[176:191], v[212:215], v[48:55], v112
    s_mov_b64 exec, s[56:57]
    global_load_dwordx4 v[208:211], v114, s[52:53] offset:3072 sc1
    global_load_dwordx4 v[212:215], v114, s[52:53] offset:3584 sc1
    s_mov_b64 exec, -1
    v_exp_f32 v26, v26
    v_exp_f32 v27, v27
    v_exp_f32 v28, v28
    v_mfma_f32_32x32x16_bf16 v[40:55], v[216:219], v[244:247], 0
    global_load_dwordx4 v[204:207], v113, s[52:53] offset:2048 sc1
    v_exp_f32 v29, v29
    v_exp_f32 v30, v30
    v_exp_f32 v31, v31
    v_exp_f32 v32, v32
    v_exp_f32 v33, v33
    v_exp_f32 v34, v34
    v_smfmac_f32_32x32x32_bf16 v[128:143], v[220:223], v[24:31], v112
    v_exp_f32 v35, v35
    v_exp_f32 v36, v36
    v_exp_f32 v37, v37
    v_exp_f32 v38, v38
    v_exp_f32 v39, v39
    v_exp_f32 v40, v40
    v_exp_f32 v41, v41
    v_smfmac_f32_32x32x32_bf16 v[128:143], v[224:227], v[32:39], v112
    s_add_u32 s54, s54, 1
    s_cmp_eq_u32 s54, s28
    v_exp_f32 v42, v42
    v_exp_f32 v43, v43
    v_exp_f32 v44, v44
    v_mfma_f32_32x32x16_bf16 v[24:39], v[216:219], v[248:251], 0
    s_addc_u32 s54, s54, 0
    v_exp_f32 v45, v45
    v_exp_f32 v46, v46
    v_exp_f32 v47, v47
    v_exp_f32 v48, v48
    v_exp_f32 v49, v49
    v_exp_f32 v50, v50
    v_smfmac_f32_32x32x32_bf16 v[144:159], v[220:223], v[40:47], v112
    s_lshl_b32 s29, s54, 13
    s_and_b32 s29, s29, 0x1e000
    v_exp_f32 v51, v51
    v_exp_f32 v52, v52
    v_exp_f32 v53, v53
    v_exp_f32 v54, v54
    v_exp_f32 v55, v55
    v_exp_f32 v24, v24
    v_exp_f32 v25, v25
    v_smfmac_f32_32x32x32_bf16 v[144:159], v[224:227], v[48:55], v112
    s_add_u32 s52, s50, s29
    s_addc_u32 s53, s51, 0
    v_exp_f32 v26, v26
    v_exp_f32 v27, v27
    v_exp_f32 v28, v28
    v_mfma_f32_32x32x16_bf16 v[40:55], v[216:219], v[252:255], 0
    v_exp_f32 v29, v29
    v_exp_f32 v30, v30
    v_exp_f32 v31, v31
    v_exp_f32 v32, v32
    v_exp_f32 v33, v33
    v_exp_f32 v34, v34
    v_smfmac_f32_32x32x32_bf16 v[160:175], v[220:223], v[24:31], v112
    v_exp_f32 v35, v35
    v_exp_f32 v36, v36
    v_exp_f32 v37, v37
    v_exp_f32 v38, v38
    v_exp_f32 v39, v39
    v_exp_f32 v40, v40
    v_exp_f32 v41, v41
    v_smfmac_f32_32x32x32_bf16 v[160:175], v[224:227], v[32:39], v112
    s_waitcnt vmcnt(6)
    s_sub_u32 s55, s55, 1
    v_exp_f32 v42, v42
    v_exp_f32 v43, v43
    v_exp_f32 v44, v44
    v_mfma_f32_32x32x16_bf16 v[24:39], v[228:231], v[240:243], 0
    s_cmp_lg_u32 s55, 0
    v_exp_f32 v45, v45
    v_exp_f32 v46, v46
    v_exp_f32 v47, v47
    v_exp_f32 v48, v48
    v_exp_f32 v49, v49
    v_exp_f32 v50, v50
    v_smfmac_f32_32x32x32_bf16 v[176:191], v[220:223], v[40:47], v112
    s_cbranch_scc0 L_last
    v_exp_f32 v51, v51
    v_exp_f32 v52, v52
    v_exp_f32 v53, v53
    v_exp_f32 v54, v54
    v_exp_f32 v55, v55
    v_exp_f32 v24, v24
    v_exp_f32 v25, v25
    v_smfmac_f32_32x32x32_bf16 v[176:191], v[224:227], v[48:55], v112
    s_mov_b64 exec, s[56:57]
    global_load_dwordx4 v[220:223], v114, s[52:53] offset:1024 sc1
    global_load_dwordx4 v[224:227], v114, s[52:53] offset:1536 sc1
    s_mov_b64 exec, -1
    v_exp_f32 v26, v26
    v_exp_f32 v27, v27
    v_exp_f32 v28, v28
    v_mfma_f32_32x32x16_bf16 v[40:55], v[228:231], v[244:247], 0
    global_load_dwordx4 v[216:219], v113, s[52:53] offset:0 sc1
    v_exp_f32 v29, v29
    v_exp_f32 v30, v30
    v_exp_f32 v31, v31
    v_exp_f32 v32, v32
    v_exp_f32 v33, v33
    v_exp_f32 v34, v34
    v_smfmac_f32_32x32x32_bf16 v[128:143], v[232:235], v[24:31], v112
    v_exp_f32 v35, v35
    v_exp_f32 v36, v36
    v_exp_f32 v37, v37
    v_exp_f32 v38, v38
    v_exp_f32 v39, v39
    v_exp_f32 v40, v40
    v_exp_f32 v41, v41
    v_smfmac_f32_32x32x32_bf16 v[128:143], v[236:239], v[32:39], v112
    v_exp_f32 v42, v42
    v_exp_f32 v43, v43
    v_exp_f32 v44, v44
    v_mfma_f32_32x32x16_bf16 v[24:39], v[228:231], v[248:251], 0
    v_exp_f32 v45, v45
    v_exp_f32 v46, v46
    v_exp_f32 v47, v47
    v_exp_f32 v48, v48
    v_exp_f32 v49, v49
    v_exp_f32 v50, v50
    v_smfmac_f32_32x32x32_bf16 v[144:159], v[232:235], v[40:47], v112
    v_exp_f32 v51, v51
    v_exp_f32 v52, v52
    v_exp_f32 v53, v53
    v_exp_f32 v54, v54
    v_exp_f32 v55, v55
    v_exp_f32 v24, v24
    v_exp_f32 v25, v25
    v_smfmac_f32_32x32x32_bf16 v[144:159], v[236:239], v[48:55], v112
    v_exp_f32 v26, v26
    v_exp_f32 v27, v27
    v_exp_f32 v28, v28
    v_mfma_f32_32x32x16_bf16 v[40:55], v[228:231], v[252:255], 0
    v_exp_f32 v29, v29
    v_exp_f32 v30, v30
    v_exp_f32 v31, v31
    v_exp_f32 v32, v32
    v_exp_f32 v33, v33
    v_exp_f32 v34, v34
    v_smfmac_f32_32x32x32_bf16 v[160:175], v[232:235], v[24:31], v112
    v_exp_f32 v35, v35
    v_exp_f32 v36, v36
    v_exp_f32 v37, v37
    v_exp_f32 v38, v38
    v_exp_f32 v39, v39
    v_exp_f32 v40, v40
    v_exp_f32 v41, v41
    v_smfmac_f32_32x32x32_bf16 v[160:175], v[236:239], v[32:39], v112
    s_waitcnt vmcnt(6)
    v_exp_f32 v42, v42
    v_exp_f32 v43, v43
    v_exp_f32 v44, v44
    v_mfma_f32_32x32x16_bf16 v[24:39], v[192:195], v[240:243], 0
    v_exp_f32 v45, v45
    v_exp_f32 v46, v46
    v_exp_f32 v47, v47
    v_exp_f32 v48, v48
    v_exp_f32 v49, v49
    v_exp_f32 v50, v50
    v_smfmac_f32_32x32x32_bf16 v[176:191], v[232:235], v[40:47], v112
    v_exp_f32 v51, v51
    v_exp_f32 v52, v52
    v_exp_f32 v53, v53
    v_exp_f32 v54, v54
    v_exp_f32 v55, v55
    v_exp_f32 v24, v24
    v_exp_f32 v25, v25
    v_smfmac_f32_32x32x32_bf16 v[176:191], v[236:239], v[48:55], v112
    s_mov_b64 exec, s[56:57]
    global_load_dwordx4 v[232:235], v114, s[52:53] offset:3072 sc1
    global_load_dwordx4 v[236:239], v114, s[52:53] offset:3584 sc1
    s_mov_b64 exec, -1
    v_exp_f32 v26, v26
    v_exp_f32 v27, v27
    v_exp_f32 v28, v28
    v_mfma_f32_32x32x16_bf16 v[40:55], v[192:195], v[244:247], 0
    global_load_dwordx4 v[228:231], v113, s[52:53] offset:2048 sc1
    v_exp_f32 v29, v29
    v_exp_f32 v30, v30
    v_exp_f32 v31, v31
    v_exp_f32 v32, v32
    v_exp_f32 v33, v33
    v_exp_f32 v34, v34
    v_smfmac_f32_32x32x32_bf16 v[128:143], v[196:199], v[24:31], v112
    v_exp_f32 v35, v35
    v_exp_f32 v36, v36
    v_exp_f32 v37, v37
    v_exp_f32 v38, v38
    v_exp_f32 v39, v39
    v_exp_f32 v40, v40
    v_exp_f32 v41, v41
    v_smfmac_f32_32x32x32_bf16 v[128:143], v[200:203], v[32:39], v112
    s_add_u32 s54, s54, 1
    s_cmp_eq_u32 s54, s28
    v_exp_f32 v42, v42
    v_exp_f32 v43, v43
    v_exp_f32 v44, v44
    v_mfma_f32_32x32x16_bf16 v[24:39], v[192:195], v[248:251], 0
    s_addc_u32 s54, s54, 0
    v_exp_f32 v45, v45
    v_exp_f32 v46, v46
    v_exp_f32 v47, v47
    v_exp_f32 v48, v48
    v_exp_f32 v49, v49
    v_exp_f32 v50, v50
    v_smfmac_f32_32x32x32_bf16 v[144:159], v[196:199], v[40:47], v112
    s_lshl_b32 s29, s54, 13
    s_and_b32 s29, s29, 0x1e000
    v_exp_f32 v51, v51
    v_exp_f32 v52, v52
    v_exp_f32 v53, v53
    v_exp_f32 v54, v54
    v_exp_f32 v55, v55
    v_exp_f32 v24, v24
    v_exp_f32 v25, v25
    v_smfmac_f32_32x32x32_bf16 v[144:159], v[200:203], v[48:55], v112
    s_add_u32 s52, s50, s29
    s_addc_u32 s53, s51, 0
    v_exp_f32 v26, v26
    v_exp_f32 v27, v27
    v_exp_f32 v28, v28
    v_mfma_f32_32x32x16_bf16 v[40:55], v[192:195], v[252:255], 0
    v_exp_f32 v29, v29
    v_exp_f32 v30, v30
    v_exp_f32 v31, v31
    v_exp_f32 v32, v32
    v_exp_f32 v33, v33
    v_exp_f32 v34, v34
    v_smfmac_f32_32x32x32_bf16 v[160:175], v[196:199], v[24:31], v112
    v_exp_f32 v35, v35
    v_exp_f32 v36, v36
    v_exp_f32 v37, v37
    v_exp_f32 v38, v38
    v_exp_f32 v39, v39
    v_exp_f32 v40, v40
    v_exp_f32 v41, v41
    v_smfmac_f32_32x32x32_bf16 v[160:175], v[200:203], v[32:39], v112
    s_waitcnt vmcnt(6)
    v_exp_f32 v42, v42
    v_exp_f32 v43, v43
    v_exp_f32 v44, v44
    v_mfma_f32_32x32x16_bf16 v[24:39], v[204:207], v[240:243], 0
    v_exp_f32 v45, v45
    v_exp_f32 v46, v46
    v_exp_f32 v47, v47
    v_exp_f32 v48, v48
    v_exp_f32 v49, v49
    v_exp_f32 v50, v50
    v_smfmac_f32_32x32x32_bf16 v[176:191], v[196:199], v[40:47], v112
    s_branch L_attn
L_last:
    v_exp_f32 v51, v51
    v_exp_f32 v52, v52
    v_exp_f32 v53, v53
    v_exp_f32 v54, v54
    v_exp_f32 v55, v55
    v_exp_f32 v24, v24
    v_exp_f32 v25, v25
    v_smfmac_f32_32x32x32_bf16 v[176:191], v[224:227], v[48:55], v112
    v_exp_f32 v26, v26
    v_exp_f32 v27, v27
    v_exp_f32 v28, v28
    v_mfma_f32_32x32x16_bf16 v[40:55], v[228:231], v[244:247], 0
    v_exp_f32 v29, v29
    v_exp_f32 v30, v30
    v_exp_f32 v31, v31
    v_exp_f32 v32, v32
    v_exp_f32 v33, v33
    v_exp_f32 v34, v34
    v_smfmac_f32_32x32x32_bf16 v[128:143], v[232:235], v[24:31], v112
    v_exp_f32 v35, v35
    v_exp_f32 v36, v36
    v_exp_f32 v37, v37
    v_exp_f32 v38, v38
    v_exp_f32 v39, v39
    v_exp_f32 v40, v40
    v_exp_f32 v41, v41
    v_smfmac_f32_32x32x32_bf16 v[128:143], v[236:239], v[32:39], v112
    s_mov_b64 exec, 1
    global_atomic_add v6, v19, v6, s[34:35] sc0 sc1
    s_mov_b64 exec, -1
    v_exp_f32 v42, v42
    v_exp_f32 v43, v43
    v_exp_f32 v44, v44
    v_mfma_f32_32x32x16_bf16 v[24:39], v[228:231], v[248:251], 0
    v_exp_f32 v45, v45
    v_exp_f32 v46, v46
    v_exp_f32 v47, v47
    v_exp_f32 v48, v48
    v_exp_f32 v49, v49
    v_exp_f32 v50, v50
    v_smfmac_f32_32x32x32_bf16 v[144:159], v[232:235], v[40:47], v112
    v_exp_f32 v51, v51
    v_exp_f32 v52, v52
    v_exp_f32 v53, v53
    v_exp_f32 v54, v54
    v_exp_f32 v55, v55
    v_exp_f32 v24, v24
    v_exp_f32 v25, v25
    v_smfmac_f32_32x32x32_bf16 v[144:159], v[236:239], v[48:55], v112
    ds_write_b128 v122, v[128:131] offset:0
    v_exp_f32 v26, v26
    v_exp_f32 v27, v27
    v_exp_f32 v28, v28
    v_mfma_f32_32x32x16_bf16 v[40:55], v[228:231], v[252:255], 0
    ds_write_b128 v122, v[132:135] offset:1024
    v_exp_f32 v29, v29
    v_exp_f32 v30, v30
    v_exp_f32 v31, v31
    v_exp_f32 v32, v32
    v_exp_f32 v33, v33
    v_exp_f32 v34, v34
    v_smfmac_f32_32x32x32_bf16 v[160:175], v[232:235], v[24:31], v112
    ds_write_b32 v123, v136 offset:4096
    v_exp_f32 v35, v35
    v_exp_f32 v36, v36
    v_exp_f32 v37, v37
    v_exp_f32 v38, v38
    v_exp_f32 v39, v39
    v_exp_f32 v40, v40
    v_exp_f32 v41, v41
    v_smfmac_f32_32x32x32_bf16 v[160:175], v[236:239], v[32:39], v112
    ds_write_b128 v122, v[144:147] offset:2048
    ds_write_b128 v122, v[148:151] offset:3072
    ds_write_b32 v123, v152 offset:4352
    v_exp_f32 v42, v42
    v_exp_f32 v43, v43
    v_exp_f32 v44, v44
    v_exp_f32 v45, v45
    v_exp_f32 v46, v46
    v_exp_f32 v47, v47
    v_exp_f32 v48, v48
    v_exp_f32 v49, v49
    v_exp_f32 v50, v50
    v_smfmac_f32_32x32x32_bf16 v[176:191], v[232:235], v[40:47], v112
    s_waitcnt lgkmcnt(0)
    s_barrier
    ds_read_b32 v80, v125 offset:4096
    ds_read_b128 v[64:67], v124
    ds_read_b128 v[68:71], v124 offset:1024
    ds_read_b32 v81, v125 offset:4352
    ds_read_b128 v[72:75], v124 offset:2048
    ds_read_b128 v[76:79], v124 offset:3072
    v_exp_f32 v51, v51
    v_exp_f32 v52, v52
    v_exp_f32 v53, v53
    v_exp_f32 v54, v54
    v_exp_f32 v55, v55
    s_waitcnt lgkmcnt(3)
    v_add_f32 v168, v168, v80
    v_smfmac_f32_32x32x32_bf16 v[176:191], v[236:239], v[48:55], v112
    v_rcp_f32 v56, v168
    v_add_f32 v160, v160, v64
    v_add_f32 v161, v161, v65
    v_add_f32 v162, v162, v66
    v_add_f32 v163, v163, v67
    v_add_f32 v164, v164, v68
    v_add_f32 v165, v165, v69
    v_add_f32 v166, v166, v70
    v_add_f32 v167, v167, v71
    v_mul_f32 v160, v160, v56
    v_mul_f32 v161, v161, v56
    v_mul_f32 v162, v162, v56
    v_mul_f32 v163, v163, v56
    v_mul_f32 v164, v164, v56
    v_mul_f32 v165, v165, v56
    v_mul_f32 v166, v166, v56
    v_mul_f32 v167, v167, v56
    v_cvt_pk_bf16_f32 v24, v160, v161
    v_cvt_pk_bf16_f32 v25, v162, v163
    v_cvt_pk_bf16_f32 v26, v164, v165
    v_cvt_pk_bf16_f32 v27, v166, v167
    global_store_dwordx4 v126, v[24:27], s[46:47] sc1
    s_waitcnt lgkmcnt(0)
    v_add_f32 v184, v184, v81
    v_rcp_f32 v56, v184
    v_pk_add_f32 v[176:177], v[176:177], v[72:73]
    v_pk_add_f32 v[178:179], v[178:179], v[74:75]
    v_pk_add_f32 v[180:181], v[180:181], v[76:77]
    v_pk_add_f32 v[182:183], v[182:183], v[78:79]
    v_pk_mul_f32 v[176:177], v[176:177], v[56:57] op_sel_hi:[1,0]
    v_pk_mul_f32 v[178:179], v[178:179], v[56:57] op_sel_hi:[1,0]
    v_pk_mul_f32 v[180:181], v[180:181], v[56:57] op_sel_hi:[1,0]
    v_pk_mul_f32 v[182:183], v[182:183], v[56:57] op_sel_hi:[1,0]
    v_cvt_pk_bf16_f32 v28, v176, v177
    v_cvt_pk_bf16_f32 v29, v178, v179
    v_cvt_pk_bf16_f32 v30, v180, v181
    v_cvt_pk_bf16_f32 v31, v182, v183
    global_store_dwordx4 v127, v[28:31], s[46:47] sc1
    s_mov_b64 exec, 1
    global_atomic_add v4, v19, v4, s[34:35] sc0 sc1
    s_mov_b64 exec, -1
    s_mov_b32 s58, 0x30800000
    s_mov_b32 s59, 0x76800000
    v_min_f32 v62, v168, v184
    v_max_f32 v63, v168, v184
    v_cmp_lt_f32 vcc, s58, v62
    v_cmp_gt_f32 s[60:61], s59, v63
    v_pk_mul_f32 v[58:59], v[160:161], 0 op_sel_hi:[1,0]
    s_and_b64 s[60:61], s[60:61], vcc
    v_pk_fma_f32 v[58:59], v[162:163], 0, v[58:59] op_sel_hi:[1,0,1]
    v_pk_fma_f32 v[58:59], v[164:165], 0, v[58:59] op_sel_hi:[1,0,1]
    v_pk_fma_f32 v[58:59], v[166:167], 0, v[58:59] op_sel_hi:[1,0,1]
    v_pk_fma_f32 v[58:59], v[176:177], 0, v[58:59] op_sel_hi:[1,0,1]
    v_pk_fma_f32 v[58:59], v[178:179], 0, v[58:59] op_sel_hi:[1,0,1]
    v_pk_fma_f32 v[58:59], v[180:181], 0, v[58:59] op_sel_hi:[1,0,1]
    v_pk_fma_f32 v[58:59], v[182:183], 0, v[58:59] op_sel_hi:[1,0,1]
    v_cmp_o_f32 vcc, v58, v59
    s_nop 1
    s_and_b64 vcc, s[60:61], vcc
    s_cmp_eq_u64 vcc, -1
    s_cbranch_scc0 L_safe
    s_waitcnt vmcnt(3)
    v_readfirstlane_b32 s58, v6
    s_nop 0
    s_bfe_u32 s58, s58, s25
    s_cmp_eq_u32 s58, 8
    s_cbranch_scc0 L_late
    global_load_lds_dwordx4 v20, s[46:47] offset:0 sc1
    global_load_lds_dwordx4 v20, s[46:47] offset:1024 sc1
    global_load_lds_dwordx4 v20, s[46:47] offset:2048 sc1
    global_load_lds_dwordx4 v20, s[46:47] offset:3072 sc1
    s_add_u32 m0, s92, 51200
    s_nop 0
    global_load_lds_dwordx4 v3, s[46:47] offset:0 sc1
    global_load_lds_dwordx4 v3, s[46:47] offset:1024 sc1
    global_load_lds_dwordx4 v3, s[46:47] offset:2048 sc1
    global_load_lds_dwordx4 v3, s[46:47] offset:3072 sc1
    s_waitcnt vmcnt(9)
    s_bfm_b64 exec, 8, 0
    global_atomic_add v17, v5, s[34:35] sc1
    s_mov_b64 exec, -1
    s_waitcnt vmcnt(1)
    s_branch L_got
L_late:
    s_waitcnt vmcnt(1)
L_pub:
    s_bfm_b64 exec, 8, 0
    global_atomic_add v17, v5, s[34:35] sc1
    s_mov_b64 exec, -1
    s_mov_b32 s62, 200000
    s_mov_b64 exec, 1
    s_branch L_pcc_3
L_pc_1:
    v_mov_b32 v4, 0
    global_atomic_add v4, v19, v4, s[34:35] sc0 sc1
    s_waitcnt vmcnt(0)
L_pcc_3:
    s_sub_u32 s62, s62, 1
    s_cbranch_scc1 L_pcd_2
    s_waitcnt vmcnt(1)
    v_readfirstlane_b32 s63, v4
    s_nop 0
    s_bfe_u32 s63, s63, s25
    s_cmp_eq_u32 s63, 8
    s_cbranch_scc0 L_pc_1
L_pcd_2:
    s_mov_b64 exec, -1
    global_load_lds_dwordx4 v20, s[46:47] offset:0 sc1
    global_load_lds_dwordx4 v20, s[46:47] offset:1024 sc1
    global_load_lds_dwordx4 v20, s[46:47] offset:2048 sc1
    global_load_lds_dwordx4 v20, s[46:47] offset:3072 sc1
    s_add_u32 m0, s92, 51200
    s_nop 0
    global_load_lds_dwordx4 v3, s[46:47] offset:0 sc1
    global_load_lds_dwordx4 v3, s[46:47] offset:1024 sc1
    global_load_lds_dwordx4 v3, s[46:47] offset:2048 sc1
    global_load_lds_dwordx4 v3, s[46:47] offset:3072 sc1
    s_waitcnt vmcnt(0)
L_got:
    ds_write_b8 v2, v18 offset:47052
    s_endpgm
L_safe:
    s_waitcnt vmcnt(0)
    s_lshl_b32 s58, s100, 12
    s_sub_u32 s50, s50, s58
    s_subb_u32 s51, s51, 0
    s_mov_b32 s52, s50
    s_mov_b32 s53, s51
    s_mov_b32 s55, 64
    v_mov_b32 v62, 0xff800000
    v_mov_b32 v63, 0xff800000
L_safe1:
    global_load_dwordx4 v[192:195], v113, s[52:53] sc1
    s_add_u32 s52, s52, 2048
    s_addc_u32 s53, s53, 0
    s_waitcnt vmcnt(0)
    v_mfma_f32_32x32x16_bf16 v[24:39], v[192:195], v[248:251], 0
    v_mfma_f32_32x32x16_bf16 v[40:55], v[192:195], v[252:255], 0
    s_nop 15
    v_max3_f32 v62, v24, v25, v62
    v_max3_f32 v63, v40, v41, v63
    v_max3_f32 v62, v26, v27, v62
    v_max3_f32 v63, v42, v43, v63
    v_max3_f32 v62, v28, v29, v62
    v_max3_f32 v63, v44, v45, v63
    v_max3_f32 v62, v30, v31, v62
    v_max3_f32 v63, v46, v47, v63
    v_max3_f32 v62, v32, v33, v62
    v_max3_f32 v63, v48, v49, v63
    v_max3_f32 v62, v34, v35, v62
    v_max3_f32 v63, v50, v51, v63
    v_max3_f32 v62, v36, v37, v62
    v_max3_f32 v63, v52, v53, v63
    v_max3_f32 v62, v38, v39, v62
    v_max3_f32 v63, v54, v55, v63
    s_sub_u32 s55, s55, 1
    s_cmp_lg_u32 s55, 0
    s_cbranch_scc1 L_safe1
    v_mov_b32 v24, v62
    v_mov_b32 v40, v63
    s_nop 1
    v_permlane32_swap_b32 v24, v62
    v_permlane32_swap_b32 v40, v63
    s_nop 1
    v_max_f32 v62, v62, v24
    v_max_f32 v63, v63, v40
    v_sub_f32 v64, 0, v62
    v_sub_f32 v80, 0, v63
    v_mov_b32 v160, 0
    v_mov_b32 v176, 0
    v_sub_f32 v65, 0, v62
    v_sub_f32 v81, 0, v63
    v_mov_b32 v161, 0
    v_mov_b32 v177, 0
    v_sub_f32 v66, 0, v62
    v_sub_f32 v82, 0, v63
    v_mov_b32 v162, 0
    v_mov_b32 v178, 0
    v_sub_f32 v67, 0, v62
    v_sub_f32 v83, 0, v63
    v_mov_b32 v163, 0
    v_mov_b32 v179, 0
    v_sub_f32 v68, 0, v62
    v_sub_f32 v84, 0, v63
    v_mov_b32 v164, 0
    v_mov_b32 v180, 0
    v_sub_f32 v69, 0, v62
    v_sub_f32 v85, 0, v63
    v_mov_b32 v165, 0
    v_mov_b32 v181, 0
    v_sub_f32 v70, 0, v62
    v_sub_f32 v86, 0, v63
    v_mov_b32 v166, 0
    v_mov_b32 v182, 0
    v_sub_f32 v71, 0, v62
    v_sub_f32 v87, 0, v63
    v_mov_b32 v167, 0
    v_mov_b32 v183, 0
    v_sub_f32 v72, 0, v62
    v_sub_f32 v88, 0, v63
    v_mov_b32 v168, 0
    v_mov_b32 v184, 0
    v_sub_f32 v73, 0, v62
    v_sub_f32 v89, 0, v63
    v_mov_b32 v169, 0
    v_mov_b32 v185, 0
    v_sub_f32 v74, 0, v62
    v_sub_f32 v90, 0, v63
    v_mov_b32 v170, 0
    v_mov_b32 v186, 0
    v_sub_f32 v75, 0, v62
    v_sub_f32 v91, 0, v63
    v_mov_b32 v171, 0
    v_mov_b32 v187, 0
    v_sub_f32 v76, 0, v62
    v_sub_f32 v92, 0, v63
    v_mov_b32 v172, 0
    v_mov_b32 v188, 0
    v_sub_f32 v77, 0, v62
    v_sub_f32 v93, 0, v63
    v_mov_b32 v173, 0
    v_mov_b32 v189, 0
    v_sub_f32 v78, 0, v62
    v_sub_f32 v94, 0, v63
    v_mov_b32 v174, 0
    v_mov_b32 v190, 0
    v_sub_f32 v79, 0, v62
    v_sub_f32 v95, 0, v63
    v_mov_b32 v175, 0
    v_mov_b32 v191, 0
    s_mov_b32 s52, s50
    s_mov_b32 s53, s51
    s_mov_b32 s55, 64
L_safe2:
    global_load_dwordx4 v[192:195], v113, s[52:53] offset:0 sc1
    s_mov_b64 exec, s[56:57]
    global_load_dwordx4 v[196:199], v114, s[52:53] offset:1024 sc1
    global_load_dwordx4 v[200:203], v114, s[52:53] offset:1536 sc1
    s_mov_b64 exec, -1
    s_add_u32 s52, s52, 2048
    s_addc_u32 s53, s53, 0
    s_waitcnt vmcnt(0)
    v_mfma_f32_32x32x16_bf16 v[24:39], v[192:195], v[248:251], v[64:79]
    v_mfma_f32_32x32x16_bf16 v[40:55], v[192:195], v[252:255], v[80:95]
    s_nop 15
    v_exp_f32 v24, v24
    v_exp_f32 v25, v25
    v_exp_f32 v26, v26
    v_exp_f32 v27, v27
    v_exp_f32 v28, v28
    v_exp_f32 v29, v29
    v_exp_f32 v30, v30
    v_exp_f32 v31, v31
    v_exp_f32 v32, v32
    v_exp_f32 v33, v33
    v_exp_f32 v34, v34
    v_exp_f32 v35, v35
    v_exp_f32 v36, v36
    v_exp_f32 v37, v37
    v_exp_f32 v38, v38
    v_exp_f32 v39, v39
    v_exp_f32 v40, v40
    v_exp_f32 v41, v41
    v_exp_f32 v42, v42
    v_exp_f32 v43, v43
    v_exp_f32 v44, v44
    v_exp_f32 v45, v45
    v_exp_f32 v46, v46
    v_exp_f32 v47, v47
    v_exp_f32 v48, v48
    v_exp_f32 v49, v49
    v_exp_f32 v50, v50
    v_exp_f32 v51, v51
    v_exp_f32 v52, v52
    v_exp_f32 v53, v53
    v_exp_f32 v54, v54
    v_exp_f32 v55, v55
    s_nop 1
    v_smfmac_f32_32x32x32_bf16 v[160:175], v[196:199], v[24:31], v112
    v_smfmac_f32_32x32x32_bf16 v[160:175], v[200:203], v[32:39], v112
    v_smfmac_f32_32x32x32_bf16 v[176:191], v[196:199], v[40:47], v112
    v_smfmac_f32_32x32x32_bf16 v[176:191], v[200:203], v[48:55], v112
    s_sub_u32 s55, s55, 1
    s_cmp_lg_u32 s55, 0
    s_cbranch_scc1 L_safe2
    s_nop 15
    v_rcp_f32 v56, v168
    s_nop 0
    v_mul_f32 v160, v160, v56
    v_mul_f32 v161, v161, v56
    v_mul_f32 v162, v162, v56
    v_mul_f32 v163, v163, v56
    v_mul_f32 v164, v164, v56
    v_mul_f32 v165, v165, v56
    v_mul_f32 v166, v166, v56
    v_mul_f32 v167, v167, v56
    v_cvt_pk_bf16_f32 v24, v160, v161
    v_cvt_pk_bf16_f32 v25, v162, v163
    v_cvt_pk_bf16_f32 v26, v164, v165
    v_cvt_pk_bf16_f32 v27, v166, v167
    global_store_dwordx4 v126, v[24:27], s[46:47] sc1
    v_rcp_f32 v56, v184
    s_nop 0
    v_mul_f32 v176, v176, v56
    v_mul_f32 v177, v177, v56
    v_mul_f32 v178, v178, v56
    v_mul_f32 v179, v179, v56
    v_mul_f32 v180, v180, v56
    v_mul_f32 v181, v181, v56
    v_mul_f32 v182, v182, v56
    v_mul_f32 v183, v183, v56
    v_cvt_pk_bf16_f32 v28, v176, v177
    v_cvt_pk_bf16_f32 v29, v178, v179
    v_cvt_pk_bf16_f32 v30, v180, v181
    v_cvt_pk_bf16_f32 v31, v182, v183
    global_store_dwordx4 v127, v[28:31], s[46:47] sc1
    s_waitcnt vmcnt(0)
    s_branch L_pub
L_helper:
    s_lshr_b32 s49, s48, 1
    s_add_u32 s53, s6, s49
    s_and_b32 s52, s4, 3
    s_lshr_b32 s51, s4, 2
    v_lshrrev_b32 v3, 5, v1
    v_lshlrev_b32 v3, 4, v3
    s_lshl_b32 s58, s7, 2
    s_add_u32 s58, s58, s48
    s_lshl_b32 s58, s58, 5
    s_add_u32 s58, s58, 44992
    v_add_u32 v155, s58, v3
    v_mov_b32 v12, 0
    v_mov_b32 v13, 0
    v_mov_b32 v14, 0
    v_mov_b32 v15, 0
    s_cmp_lt_u32 s2, 16
    s_cselect_b32 s92, s3, 0
    s_add_u32 s34, s46, 8388608
    s_addc_u32 s35, s47, 0
    s_mul_i32 s56, s49, 4576
    s_add_u32 s56, s56, 38912
    v_lshl_add_u32 v10, v1, 4, s56
    v_and_b32 v11, 1, v1
    v_lshlrev_b32 v11, 4, v11
    v_cmp_gt_u32 vcc, 30, v1
    v_add_u32 v11, 47040, v11
    v_mov_b32 v2, 0x3f803f80
    v_cndmask_b32 v10, v11, v10, vcc
    ds_write_b128 v10, v[12:15]
    v_and_b32 v11, 3, v1
    v_lshlrev_b32 v11, 2, v11
    ds_write_b32 v11, v2 offset:47072
    s_mul_i32 s56, s51, 6144
    s_add_u32 s56, s56, 47104
    v_and_b32 v10, 31, v1
    v_lshl_add_u32 v10, v10, 7, s56
    v_bfe_u32 v11, v1, 1, 3
    v_lshrrev_b32 v3, 5, v1
    v_xor_b32 v11, v11, v3
    s_lshl_b32 s56, s48, 1
    v_xor_b32 v11, s56, v11
    v_lshl_add_u32 v165, v11, 4, v10
    v_mov_b32 v164, 0
    s_lshr_b32 s61, s4, 1
    s_sub_u32 s61, s61, s7
    s_and_b32 s61, s61, 7
    s_mul_i32 s56, s61, 11
    s_lshr_b32 s56, s56, 5
    s_mul_i32 s56, s56, 3
    s_sub_u32 s56, s61, s56
    s_mul_i32 s56, s56, 24576
    s_mul_i32 s57, s48, 6144
    s_add_u32 s56, s56, s57
    s_add_u32 s56, s56, 47104
    v_and_b32 v10, 3, v1
    v_bfe_u32 v11, v1, 2, 2
    v_lshlrev_b32 v10, 3, v10
    v_sub_u32 v10, v10, v11
    v_add_u32 v10, 7, v10
    v_bfe_u32 v11, v10, 1, 3
    v_xor_b32 v11, v11, v3
    s_and_b32 s57, s4, 1
    s_lshl_b32 s57, s57, 2
    v_xor_b32 v11, s57, v11
    v_lshlrev_b32 v11, 4, v11
    v_lshl_add_u32 v11, v10, 7, v11
    v_bfe_u32 v10, v1, 4, 1
    v_lshl_add_u32 v11, v10, 3, v11
    v_add_u32 v148, s56, v11
    v_xor_b32 v149, 32, v148
    v_subrev_u32 v150, 512, v148
    v_subrev_u32 v151, 512, v149
    s_mul_i32 s56, s48, 8704
    s_add_u32 s56, s56, 0
    s_mov_b32 m0, s56
    v_and_b32 v10, 31, v1
    v_mul_u32_u24 v10, 272, v10
    v_lshl_add_u32 v10, v3, 4, v10
    v_add_u32 v17, s56, v10
    v_mov_b32 v42, 47040
    s_lshl_b32 s56, s49, 2
    s_add_u32 s56, s56, 47044
    v_mov_b32 v24, s56
    v_mov_b32 v41, 1
    v_lshlrev_b32 v23, 4, v1
    s_lshl_b32 s56, s48, 10
    s_sub_u32 s56, 38384, s56
    v_lshrrev_b32 v18, 1, v1
    v_lshlrev_b32 v19, 4, v18
    v_sub_u32 v19, s56, v19
    v_and_b32 v20, 1, v1
    v_mul_u32_u24 v21, 4576, v20
    v_add_u32 v27, v19, v21
    s_lshr_b32 s56, s6, 2
    s_lshl_b32 s56, s56, 14
    s_lshl_b32 s57, s48, 12
    s_add_u32 s56, s56, s57
    s_and_b32 s57, s5, 1
    s_lshl_b32 s57, s57, 5
    s_add_u32 s56, s56, s57
    s_add_u32 s56, s56, 10485760
    v_lshl_add_u32 v18, v18, 6, s56
    v_lshl_add_u32 v39, v20, 4, v18
    v_and_b32 v18, 15, v1
    v_add_u32 v19, 1, v18
    v_and_b32 v20, 3, v19
    v_mul_u32_u24 v20, 4160, v20
    v_lshrrev_b32 v19, 2, v19
    v_lshl_add_u32 v20, v19, 3, v20
    v_lshrrev_b32 v21, 4, v1
    v_lshlrev_b32 v22, 4, v21
    s_mul_i32 s56, s49, 17408
    s_lshl_b32 s57, s50, 8
    s_add_u32 s56, s56, s57
    s_add_u32 s56, s56, 0
    v_add3_u32 v25, v20, v22, s56
    s_mul_i32 s56, s49, 4576
    s_add_u32 s56, s56, s57
    s_add_u32 s56, s56, 35296
    v_lshlrev_b32 v19, 5, v18
    v_sub_u32 v22, v22, v19
    v_add_u32 v26, s56, v22
    s_lshl_b32 s56, s48, 12
    s_add_u32 s56, s56, 47104
    v_add_u32 v28, s56, v23
    s_xor_b32 s56, s48, 1
    s_lshl_b32 s56, s56, 12
    s_add_u32 s56, s56, 47104
    v_add_u32 v29, s56, v23
    v_lshl_add_u32 v19, v18, 5, s56
    v_lshl_add_u32 v166, v21, 3, v19
    v_add_u32 v47, 47104, v23
    v_lshrrev_b32 v19, 2, v1
    v_lshlrev_b32 v19, 15, v19
    v_and_b32 v20, 48, v23
    v_add_u32 v30, v19, v20
    s_lshl_b32 s56, s50, 20
    s_lshl_b32 s57, s53, 6
    s_add_u32 s56, s56, s57
    s_add_u32 s56, s56, 6291456
    s_add_u32 s100, s46, s56
    s_addc_u32 s101, s47, 0
    s_lshl4_add_u32 s56, s50, s4
    s_add_u32 s56, s56, 512
    s_lshl_b32 s56, s56, 8
    v_mov_b32 v31, s56
    s_mov_b32 s12, s38
    s_mov_b32 s13, s39
    s_mov_b32 s14, 524288
    s_mov_b32 s15, 0x00020000
    s_lshl_b32 s56, s52, 2
    s_add_u32 s56, s56, s48
    s_lshl_b32 s57, s56, 6
    v_lshrrev_b32 v18, 2, v1
    v_lshl_add_u32 v18, v18, 10, s57
    v_and_b32 v19, 3, v1
    v_lshl_add_u32 v32, v19, 4, v18
    s_mul_i32 s93, s48, 12288
    s_add_u32 s93, s93, 63488
    v_lshrrev_b32 v22, 5, v1
    v_lshlrev_b32 v20, 2, v22
    v_bfe_u32 v21, v1, 2, 2
    v_add_u32 v20, v20, v21
    v_lshl_add_u32 v20, v20, 6, s93
    v_lshl_add_u32 v20, v19, 3, v20
    v_bfe_u32 v21, v1, 4, 1
    v_lshl_add_u32 v33, v21, 5, v20
    s_lshr_b32 s57, s5, 3
    s_lshl4_add_u32 s57, s57, s56
    s_add_u32 s57, s57, 512
    s_lshl_b32 s57, s57, 8
    v_mov_b32 v34, s57
    s_lshl_b32 s56, s56, 5
    v_and_b32 v18, 31, v1
    s_lshl_b32 s57, s5, 2
    s_add_u32 s57, s57, s51
    s_lshl_b32 s58, s57, 15
    s_lshl_b32 s59, s56, 6
    s_add_u32 s59, s59, s58
    s_add_u32 s59, s59, 6291456
    v_lshlrev_b32 v20, 8, v22
    v_lshl_add_u32 v20, v18, 1, v20
    v_add_u32 v35, s59, v20
    s_lshl_b32 s56, s56, 1
    s_add_u32 s60, s56, s58
    s_lshl_b32 s56, s5, 2
    s_add_u32 s56, s56, s48
    s_lshl_b32 s56, s56, 8
    s_lshl_b32 s57, s4, 17
    s_add_u32 s56, s56, s57
    s_add_u32 s56, s56, 10485760
    v_and_b32 v18, 15, v1
    v_lshl_add_u32 v18, v18, 4, s56
    v_lshrrev_b32 v19, 4, v1
    v_lshl_add_u32 v152, v19, 14, v18
    v_add_u32 v153, 0x10000, v152
    v_and_b32 v18, 15, v1
    v_lshlrev_b32 v145, 2, v18
    s_lshl_b32 s56, s4, 4
    v_add_u32 v19, s56, v18
    v_lshlrev_b32 v147, 8, v19
    s_add_u32 s56, s56, s5
    s_lshr_b32 s57, s56, 2
    s_add_u32 s57, s57, 544
    s_lshl_b32 s57, s57, 8
    v_mov_b32 v143, s57
    s_lshl2_add_u32 s57, s4, s48
    s_add_u32 s57, s57, 544
    s_lshl_b32 s57, s57, 8
    v_mov_b32 v144, s57
    s_lshl_b32 s56, s56, 8
    v_mov_b32 v146, s56
    v_and_b32 v18, 31, v1
    v_lshlrev_b32 v18, 5, v18
    v_lshrrev_b32 v19, 5, v1
    v_lshl_add_u32 v19, v19, 2, v18
    s_lshl_b32 s56, s48, 3
    s_add_u32 s56, s56, 43968
    v_add_u32 v36, s56, v19
    v_add_u32 v37, 43968, v18
    s_lshr_b32 s56, s2, 3
    s_lshl_b32 s56, s56, 2
    s_add_u32 s56, s56, s48
    s_lshl_b32 s56, s56, 12
    s_lshr_b32 s57, s52, 2
    s_lshl_b32 s57, s57, 10
    s_add_u32 s56, s56, s57
    v_bfe_u32 v18, v1, 3, 2
    v_lshl_add_u32 v18, v18, 10, s56
    v_and_b32 v19, 7, v1
    v_lshl_add_u32 v38, v19, 7, v18
    v_mov_b32 v48, 0
    v_mov_b32 v49, 0
    v_mov_b32 v50, 0
    v_mov_b32 v51, 0
    v_mov_b32 v52, 0
    v_mov_b32 v53, 0
    v_mov_b32 v54, 0
    v_mov_b32 v55, 0
    v_mov_b32 v56, 0
    v_mov_b32 v57, 0
    v_mov_b32 v58, 0
    v_mov_b32 v59, 0
    v_mov_b32 v60, 0
    v_mov_b32 v61, 0
    v_mov_b32 v62, 0
    v_mov_b32 v63, 0
    s_mul_i32 s56, s49, 17408
    v_lshrrev_b32 v18, 1, v1
    v_mul_u32_u24 v18, 4160, v18
    v_and_b32 v19, 1, v1
    v_cmp_eq_u32 s[94:95], 1, v19
    v_lshlrev_b32 v19, 4, v19
    v_add3_u32 v142, v18, v19, s56
    s_lshl_b32 s57, s50, 10
    s_add_u32 s56, s56, s57
    s_add_u32 s56, s56, 32
    v_lshl_add_u32 v128, v1, 4, s56
    s_lshl_b32 s56, s48, 12
    s_add_u32 s56, s56, 49152
    v_lshl_add_u32 v141, v1, 3, s56
    v_add_u32 v129, 1024, v128
    v_add_u32 v130, 2048, v128
    v_add_u32 v131, 4160, v128
    v_add_u32 v132, 5184, v128
    v_add_u32 v133, 6208, v128
    v_add_u32 v134, 8320, v128
    v_add_u32 v135, 9344, v128
    v_add_u32 v136, 10368, v128
    v_add_u32 v137, 12480, v128
    v_add_u32 v138, 13504, v128
    v_add_u32 v139, 14528, v128
    s_waitcnt lgkmcnt(0)
    s_lshl_b32 s56, s49, 4
    s_lshr_b32 s54, s54, s56
    s_lshl_b32 s54, s54, 16
    s_lshr_b32 s55, s55, s56
    s_lshl_b32 s55, s55, 16
    s_mov_b32 s56, 0x3fb8aa3b
    v_mov_b32 v222, s54
    v_mul_f32 v223, s56, v222
    v_fma_f32 v224, v222, s56, -v223
    v_fmac_f32 v224, 0x32a57060, v222
    v_exp_f32 v223, v223
    v_mul_f32 v224, 0x3f317218, v224
    v_fma_f32 v223, v223, v224, v223
    v_cvt_pk_bf16_f32 v223, v223, v223
    v_lshlrev_b32 v222, 16, v223
    s_waitcnt vmcnt(0)
    v_lshlrev_b32 v4, 16, v4
    v_lshlrev_b32 v5, 16, v5
    v_lshlrev_b32 v6, 16, v6
    v_lshlrev_b32 v7, 16, v7
    v_lshlrev_b32 v8, 16, v8
    v_lshlrev_b32 v9, 16, v9
    v_mul_f32 v220, v222, v4
    v_mul_f32 v221, v222, v5
    v_mul_f32 v6, v222, v6
    v_mul_f32 v7, v222, v7
    v_mul_f32 v220, 0x3fb8aa3b, v220
    v_mul_f32 v221, 0.15915494, v221
    v_mul_f32 v224, 0x41000000, v221
    v_mul_f32 v223, 0x41000000, v220
    v_fract_f32 v224, v224
    v_exp_f32 v223, v223
    v_cos_f32 v234, v224
    v_sin_f32 v235, v224
    s_nop 0
    v_mul_f32 v234, v234, v223
    v_mul_f32 v235, v235, v223
    v_mul_f32 v224, 0x42000000, v221
    v_mul_f32 v223, 0x42000000, v220
    v_fract_f32 v224, v224
    v_exp_f32 v223, v223
    v_cos_f32 v228, v224
    v_sin_f32 v229, v224
    s_nop 0
    v_mul_f32 v228, v228, v223
    v_mul_f32 v229, v229, v223
    v_mov_b32 v232, 1.0
    v_mov_b32 v233, 0
    v_mov_b32 v240, v228
    v_mov_b32 v241, v229
    v_pk_mul_f32 v[236:237], v[234:235], v[234:235] op_sel_hi:[0,1]
    v_pk_mul_f32 v[242:243], v[234:235], v[228:229] op_sel_hi:[0,1]
    v_pk_fma_f32 v[236:237], v[234:235], v[234:235], v[236:237] op_sel:[1,1,0] op_sel_hi:[1,0,1] neg_lo:[1,0,0]
    v_pk_fma_f32 v[242:243], v[234:235], v[228:229], v[242:243] op_sel:[1,1,0] op_sel_hi:[1,0,1] neg_lo:[1,0,0]
    v_pk_mul_f32 v[238:239], v[236:237], v[234:235] op_sel_hi:[0,1]
    v_pk_mul_f32 v[244:245], v[236:237], v[228:229] op_sel_hi:[0,1]
    v_pk_fma_f32 v[238:239], v[236:237], v[234:235], v[238:239] op_sel:[1,1,0] op_sel_hi:[1,0,1] neg_lo:[1,0,0]
    v_pk_fma_f32 v[244:245], v[236:237], v[228:229], v[244:245] op_sel:[1,1,0] op_sel_hi:[1,0,1] neg_lo:[1,0,0]
    v_pk_mul_f32 v[246:247], v[238:239], v[228:229] op_sel_hi:[0,1]
    v_pk_fma_f32 v[246:247], v[238:239], v[228:229], v[246:247] op_sel:[1,1,0] op_sel_hi:[1,0,1] neg_lo:[1,0,0]
    v_cvt_pk_bf16_f32 v64, v232, v233
    v_cvt_pk_bf16_f32 v65, v234, v235
    v_cvt_pk_bf16_f32 v66, v236, v237
    v_cvt_pk_bf16_f32 v67, v238, v239
    v_pk_mul_f32 v[232:233], v[240:241], v[228:229] op_sel_hi:[0,1]
    v_pk_mul_f32 v[234:235], v[242:243], v[228:229] op_sel_hi:[0,1]
    v_pk_mul_f32 v[236:237], v[244:245], v[228:229] op_sel_hi:[0,1]
    v_pk_mul_f32 v[238:239], v[246:247], v[228:229] op_sel_hi:[0,1]
    v_pk_fma_f32 v[232:233], v[240:241], v[228:229], v[232:233] op_sel:[1,1,0] op_sel_hi:[1,0,1] neg_lo:[1,0,0]
    v_pk_fma_f32 v[234:235], v[242:243], v[228:229], v[234:235] op_sel:[1,1,0] op_sel_hi:[1,0,1] neg_lo:[1,0,0]
    v_pk_fma_f32 v[236:237], v[244:245], v[228:229], v[236:237] op_sel:[1,1,0] op_sel_hi:[1,0,1] neg_lo:[1,0,0]
    v_pk_fma_f32 v[238:239], v[246:247], v[228:229], v[238:239] op_sel:[1,1,0] op_sel_hi:[1,0,1] neg_lo:[1,0,0]
    v_cvt_pk_bf16_f32 v68, v240, v241
    v_cvt_pk_bf16_f32 v69, v242, v243
    v_cvt_pk_bf16_f32 v70, v244, v245
    v_cvt_pk_bf16_f32 v71, v246, v247
    v_pk_mul_f32 v[240:241], v[232:233], v[228:229] op_sel_hi:[0,1]
    v_pk_mul_f32 v[242:243], v[234:235], v[228:229] op_sel_hi:[0,1]
    v_pk_mul_f32 v[244:245], v[236:237], v[228:229] op_sel_hi:[0,1]
    v_pk_mul_f32 v[246:247], v[238:239], v[228:229] op_sel_hi:[0,1]
    v_pk_fma_f32 v[240:241], v[232:233], v[228:229], v[240:241] op_sel:[1,1,0] op_sel_hi:[1,0,1] neg_lo:[1,0,0]
    s_waitcnt lgkmcnt(0)
    s_barrier
    ds_read_b128 v[160:163], v165 offset:0
    ds_read_b128 v[156:159], v155 offset:0
    s_cmp_eq_u32 s61, 0
    s_cbranch_scc0 L_ut0
    ds_read_b64_tr_b16 v[168:169], v148
    ds_read_b64_tr_b16 v[170:171], v151
    ds_read_b64_tr_b16 v[172:173], v149
    ds_read_b64_tr_b16 v[174:175], v150
L_ut0:
    v_pk_fma_f32 v[242:243], v[234:235], v[228:229], v[242:243] op_sel:[1,1,0] op_sel_hi:[1,0,1] neg_lo:[1,0,0]
    v_pk_fma_f32 v[244:245], v[236:237], v[228:229], v[244:245] op_sel:[1,1,0] op_sel_hi:[1,0,1] neg_lo:[1,0,0]
    v_pk_fma_f32 v[246:247], v[238:239], v[228:229], v[246:247] op_sel:[1,1,0] op_sel_hi:[1,0,1] neg_lo:[1,0,0]
    v_cvt_pk_bf16_f32 v72, v232, v233
    v_cvt_pk_bf16_f32 v73, v234, v235
    v_cvt_pk_bf16_f32 v74, v236, v237
    v_cvt_pk_bf16_f32 v75, v238, v239
    v_pk_mul_f32 v[232:233], v[240:241], v[228:229] op_sel_hi:[0,1]
    v_pk_mul_f32 v[234:235], v[242:243], v[228:229] op_sel_hi:[0,1]
    v_pk_mul_f32 v[236:237], v[244:245], v[228:229] op_sel_hi:[0,1]
    v_pk_mul_f32 v[238:239], v[246:247], v[228:229] op_sel_hi:[0,1]
    v_pk_fma_f32 v[232:233], v[240:241], v[228:229], v[232:233] op_sel:[1,1,0] op_sel_hi:[1,0,1] neg_lo:[1,0,0]
    v_pk_fma_f32 v[234:235], v[242:243], v[228:229], v[234:235] op_sel:[1,1,0] op_sel_hi:[1,0,1] neg_lo:[1,0,0]
    v_pk_fma_f32 v[236:237], v[244:245], v[228:229], v[236:237] op_sel:[1,1,0] op_sel_hi:[1,0,1] neg_lo:[1,0,0]
    v_pk_fma_f32 v[238:239], v[246:247], v[228:229], v[238:239] op_sel:[1,1,0] op_sel_hi:[1,0,1] neg_lo:[1,0,0]
    v_cvt_pk_bf16_f32 v76, v240, v241
    v_cvt_pk_bf16_f32 v77, v242, v243
    v_cvt_pk_bf16_f32 v78, v244, v245
    v_cvt_pk_bf16_f32 v79, v246, v247
    v_pk_mul_f32 v[240:241], v[232:233], v[228:229] op_sel_hi:[0,1]
    v_pk_mul_f32 v[242:243], v[234:235], v[228:229] op_sel_hi:[0,1]
    v_pk_mul_f32 v[244:245], v[236:237], v[228:229] op_sel_hi:[0,1]
    v_pk_mul_f32 v[246:247], v[238:239], v[228:229] op_sel_hi:[0,1]
    v_pk_fma_f32 v[240:241], v[232:233], v[228:229], v[240:241] op_sel:[1,1,0] op_sel_hi:[1,0,1] neg_lo:[1,0,0]
    v_pk_fma_f32 v[242:243], v[234:235], v[228:229], v[242:243] op_sel:[1,1,0] op_sel_hi:[1,0,1] neg_lo:[1,0,0]
    v_pk_fma_f32 v[244:245], v[236:237], v[228:229], v[244:245] op_sel:[1,1,0] op_sel_hi:[1,0,1] neg_lo:[1,0,0]
    v_pk_fma_f32 v[246:247], v[238:239], v[228:229], v[246:247] op_sel:[1,1,0] op_sel_hi:[1,0,1] neg_lo:[1,0,0]
    v_cvt_pk_bf16_f32 v80, v232, v233
    v_cvt_pk_bf16_f32 v81, v234, v235
    v_cvt_pk_bf16_f32 v82, v236, v237
    v_cvt_pk_bf16_f32 v83, v238, v239
    v_pk_mul_f32 v[232:233], v[240:241], v[228:229] op_sel_hi:[0,1]
    v_pk_mul_f32 v[234:235], v[242:243], v[228:229] op_sel_hi:[0,1]
    v_pk_mul_f32 v[236:237], v[244:245], v[228:229] op_sel_hi:[0,1]
    v_pk_mul_f32 v[238:239], v[246:247], v[228:229] op_sel_hi:[0,1]
    v_pk_fma_f32 v[232:233], v[240:241], v[228:229], v[232:233] op_sel:[1,1,0] op_sel_hi:[1,0,1] neg_lo:[1,0,0]
    v_pk_fma_f32 v[234:235], v[242:243], v[228:229], v[234:235] op_sel:[1,1,0] op_sel_hi:[1,0,1] neg_lo:[1,0,0]
    v_pk_fma_f32 v[236:237], v[244:245], v[228:229], v[236:237] op_sel:[1,1,0] op_sel_hi:[1,0,1] neg_lo:[1,0,0]
    v_pk_fma_f32 v[238:239], v[246:247], v[228:229], v[238:239] op_sel:[1,1,0] op_sel_hi:[1,0,1] neg_lo:[1,0,0]
    v_cvt_pk_bf16_f32 v84, v240, v241
    v_cvt_pk_bf16_f32 v85, v242, v243
    v_cvt_pk_bf16_f32 v86, v244, v245
    v_cvt_pk_bf16_f32 v87, v246, v247
    v_pk_mul_f32 v[240:241], v[232:233], v[228:229] op_sel_hi:[0,1]
    v_pk_mul_f32 v[242:243], v[234:235], v[228:229] op_sel_hi:[0,1]
    v_pk_mul_f32 v[244:245], v[236:237], v[228:229] op_sel_hi:[0,1]
    v_pk_mul_f32 v[246:247], v[238:239], v[228:229] op_sel_hi:[0,1]
    v_pk_fma_f32 v[240:241], v[232:233], v[228:229], v[240:241] op_sel:[1,1,0] op_sel_hi:[1,0,1] neg_lo:[1,0,0]
    v_pk_fma_f32 v[242:243], v[234:235], v[228:229], v[242:243] op_sel:[1,1,0] op_sel_hi:[1,0,1] neg_lo:[1,0,0]
    v_pk_fma_f32 v[244:245], v[236:237], v[228:229], v[244:245] op_sel:[1,1,0] op_sel_hi:[1,0,1] neg_lo:[1,0,0]
    v_pk_fma_f32 v[246:247], v[238:239], v[228:229], v[246:247] op_sel:[1,1,0] op_sel_hi:[1,0,1] neg_lo:[1,0,0]
    v_cvt_pk_bf16_f32 v88, v232, v233
    v_cvt_pk_bf16_f32 v89, v234, v235
    v_cvt_pk_bf16_f32 v90, v236, v237
    v_cvt_pk_bf16_f32 v91, v238, v239
    v_cvt_pk_bf16_f32 v92, v240, v241
    v_cvt_pk_bf16_f32 v93, v242, v243
    v_cvt_pk_bf16_f32 v94, v244, v245
    v_cvt_pk_bf16_f32 v95, v246, v247
    v_mul_f32 v224, 0x3f800000, v221
    v_mul_f32 v223, 0x3f800000, v220
    v_fract_f32 v224, v224
    v_exp_f32 v223, v223
    v_cos_f32 v226, v224
    v_sin_f32 v227, v224
    s_nop 0
    v_mul_f32 v226, v226, v223
    v_mul_f32 v227, v227, v223
    v_mul_f32 v224, 0x43800000, v221
    v_mul_f32 v223, 0x43800000, v220
    v_fract_f32 v224, v224
    v_exp_f32 v223, v223
    v_cos_f32 v230, v224
    v_sin_f32 v231, v224
    s_nop 0
    v_mul_f32 v230, v230, v223
    v_mul_f32 v231, v231, v223
    v_pk_mul_f32 v[192:193], v[8:9], v[6:7] op_sel_hi:[0,1]
    v_pk_mul_f32 v[232:233], v[226:227], v[226:227] op_sel_hi:[0,1]
    v_pk_fma_f32 v[192:193], v[8:9], v[6:7], v[192:193] op_sel:[1,1,0] op_sel_hi:[1,0,1] neg_lo:[1,0,0]
    v_pk_fma_f32 v[232:233], v[226:227], v[226:227], v[232:233] op_sel:[1,1,0] op_sel_hi:[1,0,1] neg_lo:[1,0,0]
    v_pk_mul_f32 v[194:195], v[192:193], v[226:227] op_sel_hi:[0,1]
    v_pk_mul_f32 v[196:197], v[192:193], v[232:233] op_sel_hi:[0,1]
    v_pk_fma_f32 v[194:195], v[192:193], v[226:227], v[194:195] op_sel:[1,1,0] op_sel_hi:[1,0,1] neg_lo:[1,0,0]
    v_pk_fma_f32 v[196:197], v[192:193], v[232:233], v[196:197] op_sel:[1,1,0] op_sel_hi:[1,0,1] neg_lo:[1,0,0]
    v_pk_mul_f32 v[198:199], v[194:195], v[232:233] op_sel_hi:[0,1]
    v_pk_mul_f32 v[200:201], v[196:197], v[232:233] op_sel_hi:[0,1]
    v_pk_fma_f32 v[198:199], v[194:195], v[232:233], v[198:199] op_sel:[1,1,0] op_sel_hi:[1,0,1] neg_lo:[1,0,0]
    v_pk_fma_f32 v[200:201], v[196:197], v[232:233], v[200:201] op_sel:[1,1,0] op_sel_hi:[1,0,1] neg_lo:[1,0,0]
    v_cvt_pk_bf16_f32 v96, v192, -v193
    v_cvt_pk_bf16_f32 v97, v194, -v195
    v_cvt_pk_bf16_f32 v98, v196, -v197
    v_cvt_pk_bf16_f32 v99, v198, -v199
    v_pk_mul_f32 v[202:203], v[198:199], v[232:233] op_sel_hi:[0,1]
    v_pk_mul_f32 v[204:205], v[200:201], v[232:233] op_sel_hi:[0,1]
    v_pk_fma_f32 v[202:203], v[198:199], v[232:233], v[202:203] op_sel:[1,1,0] op_sel_hi:[1,0,1] neg_lo:[1,0,0]
    v_pk_fma_f32 v[204:205], v[200:201], v[232:233], v[204:205] op_sel:[1,1,0] op_sel_hi:[1,0,1] neg_lo:[1,0,0]
    v_pk_mul_f32 v[206:207], v[202:203], v[232:233] op_sel_hi:[0,1]
    v_pk_mul_f32 v[208:209], v[204:205], v[232:233] op_sel_hi:[0,1]
    v_pk_fma_f32 v[206:207], v[202:203], v[232:233], v[206:207] op_sel:[1,1,0] op_sel_hi:[1,0,1] neg_lo:[1,0,0]
    v_pk_fma_f32 v[208:209], v[204:205], v[232:233], v[208:209] op_sel:[1,1,0] op_sel_hi:[1,0,1] neg_lo:[1,0,0]
    v_cvt_pk_bf16_f32 v100, v200, -v201
    v_cvt_pk_bf16_f32 v101, v202, -v203
    v_cvt_pk_bf16_f32 v102, v204, -v205
    v_cvt_pk_bf16_f32 v103, v206, -v207
    v_pk_mul_f32 v[210:211], v[192:193], v[230:231] op_sel_hi:[0,1]
    v_pk_mul_f32 v[212:213], v[196:197], v[230:231] op_sel_hi:[0,1]
    v_pk_mul_f32 v[214:215], v[200:201], v[230:231] op_sel_hi:[0,1]
    v_pk_mul_f32 v[216:217], v[204:205], v[230:231] op_sel_hi:[0,1]
    v_pk_mul_f32 v[218:219], v[208:209], v[230:231] op_sel_hi:[0,1]
    v_pk_fma_f32 v[210:211], v[192:193], v[230:231], v[210:211] op_sel:[1,1,0] op_sel_hi:[1,0,1] neg_lo:[1,0,0]
    v_pk_fma_f32 v[212:213], v[196:197], v[230:231], v[212:213] op_sel:[1,1,0] op_sel_hi:[1,0,1] neg_lo:[1,0,0]
    v_pk_fma_f32 v[214:215], v[200:201], v[230:231], v[214:215] op_sel:[1,1,0] op_sel_hi:[1,0,1] neg_lo:[1,0,0]
    v_pk_fma_f32 v[216:217], v[204:205], v[230:231], v[216:217] op_sel:[1,1,0] op_sel_hi:[1,0,1] neg_lo:[1,0,0]
    v_pk_fma_f32 v[218:219], v[208:209], v[230:231], v[218:219] op_sel:[1,1,0] op_sel_hi:[1,0,1] neg_lo:[1,0,0]
    v_cvt_pk_bf16_f32 v104, v210, -v211
    v_cvt_pk_bf16_f32 v105, v212, -v213
    v_cvt_pk_bf16_f32 v106, v214, -v215
    v_cvt_pk_bf16_f32 v107, v216, -v217
    v_cvt_pk_bf16_f32 v108, v218, -v219
    v_pk_mul_f32 v[192:193], v[210:211], v[230:231] op_sel_hi:[0,1]
    v_pk_mul_f32 v[200:201], v[214:215], v[230:231] op_sel_hi:[0,1]
    v_pk_mul_f32 v[208:209], v[218:219], v[230:231] op_sel_hi:[0,1]
    v_pk_fma_f32 v[192:193], v[210:211], v[230:231], v[192:193] op_sel:[1,1,0] op_sel_hi:[1,0,1] neg_lo:[1,0,0]
    v_pk_fma_f32 v[200:201], v[214:215], v[230:231], v[200:201] op_sel:[1,1,0] op_sel_hi:[1,0,1] neg_lo:[1,0,0]
    v_pk_fma_f32 v[208:209], v[218:219], v[230:231], v[208:209] op_sel:[1,1,0] op_sel_hi:[1,0,1] neg_lo:[1,0,0]
    v_cvt_pk_bf16_f32 v109, v192, -v193
    v_cvt_pk_bf16_f32 v110, v200, -v201
    v_cvt_pk_bf16_f32 v111, v208, -v209
    v_pk_mul_f32 v[210:211], v[192:193], v[230:231] op_sel_hi:[0,1]
    v_pk_mul_f32 v[214:215], v[200:201], v[230:231] op_sel_hi:[0,1]
    v_pk_mul_f32 v[218:219], v[208:209], v[230:231] op_sel_hi:[0,1]
    v_pk_fma_f32 v[210:211], v[192:193], v[230:231], v[210:211] op_sel:[1,1,0] op_sel_hi:[1,0,1] neg_lo:[1,0,0]
    v_pk_fma_f32 v[214:215], v[200:201], v[230:231], v[214:215] op_sel:[1,1,0] op_sel_hi:[1,0,1] neg_lo:[1,0,0]
    v_pk_fma_f32 v[218:219], v[208:209], v[230:231], v[218:219] op_sel:[1,1,0] op_sel_hi:[1,0,1] neg_lo:[1,0,0]
    v_cvt_pk_bf16_f32 v112, v210, -v211
    v_cvt_pk_bf16_f32 v113, v214, -v215
    v_cvt_pk_bf16_f32 v114, v218, -v219
    v_pk_mul_f32 v[192:193], v[210:211], v[230:231] op_sel_hi:[0,1]
    v_pk_mul_f32 v[208:209], v[218:219], v[230:231] op_sel_hi:[0,1]
    v_pk_fma_f32 v[192:193], v[210:211], v[230:231], v[192:193] op_sel:[1,1,0] op_sel_hi:[1,0,1] neg_lo:[1,0,0]
    v_pk_fma_f32 v[208:209], v[218:219], v[230:231], v[208:209] op_sel:[1,1,0] op_sel_hi:[1,0,1] neg_lo:[1,0,0]
    v_cvt_pk_bf16_f32 v115, v192, -v193
    v_cvt_pk_bf16_f32 v116, v208, -v209
    v_pk_mul_f32 v[210:211], v[192:193], v[230:231] op_sel_hi:[0,1]
    v_pk_mul_f32 v[218:219], v[208:209], v[230:231] op_sel_hi:[0,1]
    v_pk_fma_f32 v[210:211], v[192:193], v[230:231], v[210:211] op_sel:[1,1,0] op_sel_hi:[1,0,1] neg_lo:[1,0,0]
    v_pk_fma_f32 v[218:219], v[208:209], v[230:231], v[218:219] op_sel:[1,1,0] op_sel_hi:[1,0,1] neg_lo:[1,0,0]
    v_cvt_pk_bf16_f32 v117, v210, -v211
    v_cvt_pk_bf16_f32 v118, v218, -v219
    v_pk_mul_f32 v[192:193], v[210:211], v[230:231] op_sel_hi:[0,1]
    v_pk_mul_f32 v[208:209], v[218:219], v[230:231] op_sel_hi:[0,1]
    v_pk_fma_f32 v[192:193], v[210:211], v[230:231], v[192:193] op_sel:[1,1,0] op_sel_hi:[1,0,1] neg_lo:[1,0,0]
    v_pk_fma_f32 v[208:209], v[218:219], v[230:231], v[208:209] op_sel:[1,1,0] op_sel_hi:[1,0,1] neg_lo:[1,0,0]
    v_cvt_pk_bf16_f32 v119, v192, -v193
    v_cvt_pk_bf16_f32 v120, v208, -v209
    v_pk_mul_f32 v[210:211], v[192:193], v[230:231] op_sel_hi:[0,1]
    v_pk_mul_f32 v[218:219], v[208:209], v[230:231] op_sel_hi:[0,1]
    v_pk_fma_f32 v[210:211], v[192:193], v[230:231], v[210:211] op_sel:[1,1,0] op_sel_hi:[1,0,1] neg_lo:[1,0,0]
    v_pk_fma_f32 v[218:219], v[208:209], v[230:231], v[218:219] op_sel:[1,1,0] op_sel_hi:[1,0,1] neg_lo:[1,0,0]
    v_cvt_pk_bf16_f32 v121, v210, -v211
    v_cvt_pk_bf16_f32 v122, v218, -v219
    s_waitcnt lgkmcnt(0)
    s_barrier
    s_cmp_eq_u32 s92, 7
    s_cbranch_scc0 L_nr_4
    s_mul_i32 s62, s2, 40
    v_add_lshl_u32 v10, v1, s62, 8
    s_bfm_b64 exec, 40, 0
    global_store_dword v10, v12, s[34:35] sc1
    s_mov_b64 exec, -1
L_nr_4:
    v_dot2_f32_bf16 v164, v160, v156, v164
    v_dot2_f32_bf16 v164, v161, v157, v164
    v_dot2_f32_bf16 v164, v162, v158, v164
    v_dot2_f32_bf16 v164, v163, v159, v164
    ds_read_b128 v[160:163], v165 offset:24576
    ds_read_b128 v[156:159], v155 offset:128
    s_cmp_eq_u32 s61, 1
    s_cbranch_scc0 L_ut1
    ds_read_b64_tr_b16 v[168:169], v148
    ds_read_b64_tr_b16 v[170:171], v151
    ds_read_b64_tr_b16 v[172:173], v149
    ds_read_b64_tr_b16 v[174:175], v150
L_ut1:
    s_waitcnt lgkmcnt(0)
    s_barrier
    v_dot2_f32_bf16 v164, v160, v156, v164
    v_dot2_f32_bf16 v164, v161, v157, v164
    v_dot2_f32_bf16 v164, v162, v158, v164
    v_dot2_f32_bf16 v164, v163, v159, v164
    ds_read_b128 v[160:163], v165 offset:49152
    ds_read_b128 v[156:159], v155 offset:256
    s_cmp_eq_u32 s61, 2
    s_cbranch_scc0 L_ut2
    ds_read_b64_tr_b16 v[168:169], v148
    ds_read_b64_tr_b16 v[170:171], v151
    ds_read_b64_tr_b16 v[172:173], v149
    ds_read_b64_tr_b16 v[174:175], v150
L_ut2:
    s_waitcnt lgkmcnt(0)
    s_barrier
    s_cmp_eq_u32 s92, 7
    s_cbranch_scc0 L_nr_5
    s_lshl_b32 s62, s2, 2
    v_mov_b32 v10, s62
    v_mov_b32 v11, 1
    s_waitcnt vmcnt(0)
    s_mov_b64 exec, 1
    global_store_dword v10, v11, s[44:45] sc1
    s_mov_b64 exec, -1
L_nr_5:
    v_dot2_f32_bf16 v164, v160, v156, v164
    v_dot2_f32_bf16 v164, v161, v157, v164
    v_dot2_f32_bf16 v164, v162, v158, v164
    v_dot2_f32_bf16 v164, v163, v159, v164
    ds_read_b128 v[160:163], v165 offset:0
    ds_read_b128 v[156:159], v155 offset:384
    s_cmp_eq_u32 s61, 3
    s_cbranch_scc0 L_ut3
    ds_read_b64_tr_b16 v[168:169], v148
    ds_read_b64_tr_b16 v[170:171], v151
    ds_read_b64_tr_b16 v[172:173], v149
    ds_read_b64_tr_b16 v[174:175], v150
L_ut3:
    s_waitcnt lgkmcnt(0)
    s_barrier
    v_dot2_f32_bf16 v164, v160, v156, v164
    v_dot2_f32_bf16 v164, v161, v157, v164
    v_dot2_f32_bf16 v164, v162, v158, v164
    v_dot2_f32_bf16 v164, v163, v159, v164
    ds_read_b128 v[160:163], v165 offset:24576
    ds_read_b128 v[156:159], v155 offset:512
    s_cmp_eq_u32 s61, 4
    s_cbranch_scc0 L_ut4
    ds_read_b64_tr_b16 v[168:169], v148
    ds_read_b64_tr_b16 v[170:171], v151
    ds_read_b64_tr_b16 v[172:173], v149
    ds_read_b64_tr_b16 v[174:175], v150
L_ut4:
    s_waitcnt lgkmcnt(0)
    s_barrier
    v_dot2_f32_bf16 v164, v160, v156, v164
    v_dot2_f32_bf16 v164, v161, v157, v164
    v_dot2_f32_bf16 v164, v162, v158, v164
    v_dot2_f32_bf16 v164, v163, v159, v164
    ds_read_b128 v[160:163], v165 offset:49152
    ds_read_b128 v[156:159], v155 offset:640
    s_cmp_eq_u32 s61, 5
    s_cbranch_scc0 L_ut5
    ds_read_b64_tr_b16 v[168:169], v148
    ds_read_b64_tr_b16 v[170:171], v151
    ds_read_b64_tr_b16 v[172:173], v149
    ds_read_b64_tr_b16 v[174:175], v150
L_ut5:
    s_waitcnt lgkmcnt(0)
    s_barrier
    v_dot2_f32_bf16 v164, v160, v156, v164
    v_dot2_f32_bf16 v164, v161, v157, v164
    v_dot2_f32_bf16 v164, v162, v158, v164
    v_dot2_f32_bf16 v164, v163, v159, v164
    ds_read_b128 v[160:163], v165 offset:0
    ds_read_b128 v[156:159], v155 offset:768
    s_cmp_eq_u32 s61, 6
    s_cbranch_scc0 L_ut6
    ds_read_b64_tr_b16 v[168:169], v148
    ds_read_b64_tr_b16 v[170:171], v151
    ds_read_b64_tr_b16 v[172:173], v149
    ds_read_b64_tr_b16 v[174:175], v150
L_ut6:
    s_waitcnt lgkmcnt(0)
    s_barrier
    v_dot2_f32_bf16 v164, v160, v156, v164
    v_dot2_f32_bf16 v164, v161, v157, v164
    v_dot2_f32_bf16 v164, v162, v158, v164
    v_dot2_f32_bf16 v164, v163, v159, v164
    ds_read_b128 v[160:163], v165 offset:24576
    ds_read_b128 v[156:159], v155 offset:896
    s_cmp_eq_u32 s61, 7
    s_cbranch_scc0 L_ut7
    ds_read_b64_tr_b16 v[168:169], v148
    ds_read_b64_tr_b16 v[170:171], v151
    ds_read_b64_tr_b16 v[172:173], v149
    ds_read_b64_tr_b16 v[174:175], v150
L_ut7:
    s_waitcnt lgkmcnt(0)
    v_dot2_f32_bf16 v164, v160, v156, v164
    v_dot2_f32_bf16 v164, v161, v157, v164
    v_dot2_f32_bf16 v164, v162, v158, v164
    v_dot2_f32_bf16 v164, v163, v159, v164
    s_nop 2
    ds_write_b32 v36, v164
    global_load_dword v43, v145, s[44:45] sc1
    s_setprio 0
    s_waitcnt lgkmcnt(0)
    s_barrier
    ds_read_b128 v[4:7], v37
    ds_read_b128 v[8:11], v37 offset:16
    s_waitcnt lgkmcnt(0)
    v_add_f32 v4, v4, v5
    v_add_f32 v6, v6, v7
    v_add_f32 v8, v8, v9
    v_add_f32 v10, v10, v11
    v_add_f32 v4, v4, v6
    v_add_f32 v8, v8, v10
    v_add_f32 v4, v4, v8
    v_mul_f32 v4, 0xbfb8aa3b, v4
    v_exp_f32 v4, v4
    s_nop 0
    v_add_f32 v4, 1.0, v4
    v_rcp_f32 v45, v4
    s_nop 0
    v_sub_f32 v44, 1.0, v45
    s_barrier
    s_setprio 2
    s_waitcnt vmcnt(0)
    s_barrier
    s_cmp_lg_u32 s48, 1
    s_cbranch_scc1 L_nf_6
    v_cmp_ne_u32 vcc, 0, v43
    s_nop 1
    s_cmp_eq_u64 vcc, -1
    s_cbranch_scc1 L_rdy_7
    s_mov_b32 s62, 200000
L_poll_8:
    global_load_dword v43, v145, s[44:45] sc1
    s_sub_u32 s62, s62, 1
    s_cbranch_scc1 L_polld_9
    s_waitcnt vmcnt(0)
    v_cmp_ne_u32 vcc, 0, v43
    s_nop 1
    s_cmp_eq_u64 vcc, -1
    s_cbranch_scc0 L_poll_8
L_polld_9:
    s_waitcnt vmcnt(0)
L_rdy_7:
    s_bfm_b64 exec, 16, 0
    global_atomic_add v147, v41, s[34:35] sc1
    s_mov_b64 exec, -1
    v_mov_b32 v4, 0
    s_mov_b64 exec, 1
    global_atomic_add v4, v146, v4, s[34:35] sc0 sc1
    s_mov_b64 exec, -1
L_nf_6:
    s_barrier
    s_cmp_lg_u32 s48, 1
    s_cbranch_scc1 L_nf_10
    s_mov_b32 s62, 200000
    s_mov_b64 exec, 1
    s_branch L_pcc_13
L_pc_11:
    v_mov_b32 v4, 0
    global_atomic_add v4, v146, v4, s[34:35] sc0 sc1
L_pcc_13:
    s_sub_u32 s62, s62, 1
    s_cbranch_scc1 L_pcd_12
    s_waitcnt vmcnt(0)
    v_readfirstlane_b32 s63, v4
    s_nop 0
    s_cmp_eq_u32 s63, 16
    s_cbranch_scc0 L_pc_11
L_pcd_12:
    s_mov_b64 exec, -1
L_nf_10:
    s_setprio 0
    s_barrier
    ds_write_addtid_b32 v64 offset:0
    ds_write_addtid_b32 v65 offset:272
    ds_write_addtid_b32 v66 offset:544
    ds_write_addtid_b32 v67 offset:816
    ds_write_addtid_b32 v68 offset:1088
    ds_write_addtid_b32 v69 offset:1360
    ds_write_addtid_b32 v70 offset:1632
    ds_write_addtid_b32 v71 offset:1904
    ds_write_addtid_b32 v72 offset:2176
    ds_write_addtid_b32 v73 offset:2448
    ds_write_addtid_b32 v74 offset:2720
    ds_write_addtid_b32 v75 offset:2992
    ds_write_addtid_b32 v76 offset:3264
    ds_write_addtid_b32 v77 offset:3536
    ds_write_addtid_b32 v78 offset:3808
    ds_write_addtid_b32 v79 offset:4080
    ds_write_addtid_b32 v80 offset:4352
    ds_write_addtid_b32 v81 offset:4624
    ds_write_addtid_b32 v82 offset:4896
    ds_write_addtid_b32 v83 offset:5168
    ds_write_addtid_b32 v84 offset:5440
    ds_write_addtid_b32 v85 offset:5712
    ds_write_addtid_b32 v86 offset:5984
    ds_write_addtid_b32 v87 offset:6256
    ds_write_addtid_b32 v88 offset:6528
    ds_write_addtid_b32 v89 offset:6800
    ds_write_addtid_b32 v90 offset:7072
    ds_write_addtid_b32 v91 offset:7344
    ds_write_addtid_b32 v92 offset:7616
    ds_write_addtid_b32 v93 offset:7888
    ds_write_addtid_b32 v94 offset:8160
    ds_write_addtid_b32 v95 offset:8432
    ds_read_b128 v[192:195], v17 offset:0
    ds_read_b128 v[196:199], v17 offset:32
    ds_read_b128 v[200:203], v17 offset:64
    ds_read_b128 v[204:207], v17 offset:96
    ds_read_b128 v[208:211], v17 offset:128
    ds_read_b128 v[212:215], v17 offset:160
    ds_read_b128 v[216:219], v17 offset:192
    ds_read_b128 v[220:223], v17 offset:224
    s_waitcnt lgkmcnt(0)
    global_store_dwordx4 v152, v[168:171], s[46:47] sc1
    global_store_dwordx4 v153, v[172:175], s[46:47] sc1
    ds_write_addtid_b32 v96 offset:0
    ds_write_addtid_b32 v97 offset:272
    ds_write_addtid_b32 v98 offset:544
    ds_write_addtid_b32 v99 offset:816
    ds_write_addtid_b32 v100 offset:2176
    ds_write_addtid_b32 v101 offset:2448
    ds_write_addtid_b32 v102 offset:2720
    ds_write_addtid_b32 v103 offset:2992
    ds_write_addtid_b32 v104 offset:1088
    ds_write_addtid_b32 v104 offset:1360
    ds_write_addtid_b32 v105 offset:1632
    ds_write_addtid_b32 v106 offset:1904
    ds_write_addtid_b32 v106 offset:3264
    ds_write_addtid_b32 v106 offset:3536
    ds_write_addtid_b32 v107 offset:3808
    ds_write_addtid_b32 v108 offset:4080
    ds_write_addtid_b32 v109 offset:4352
    ds_write_addtid_b32 v110 offset:4624
    ds_write_addtid_b32 v111 offset:4896
    ds_write_addtid_b32 v112 offset:5440
    ds_write_addtid_b32 v113 offset:5712
    ds_write_addtid_b32 v114 offset:5984
    ds_write_addtid_b32 v115 offset:5168
    ds_write_addtid_b32 v116 offset:6528
    ds_write_addtid_b32 v117 offset:6256
    ds_write_addtid_b32 v118 offset:7616
    ds_write_addtid_b32 v119 offset:6800
    ds_write_addtid_b32 v120 offset:7072
    ds_write_addtid_b32 v121 offset:7888
    ds_write_addtid_b32 v122 offset:8160
    ds_read_b128 v[224:227], v17 offset:0
    ds_read_b128 v[228:231], v17 offset:32
    ds_read_b128 v[232:235], v17 offset:64
    ds_read_b128 v[236:239], v17 offset:96
    ds_read_b128 v[240:243], v17 offset:128
    ds_read_b128 v[244:247], v17 offset:160
    ds_read_b128 v[248:251], v17 offset:192
    ds_read_b128 v[252:255], v17 offset:224
    s_waitcnt vmcnt(0)
    s_bfm_b64 exec, 1, 0
    global_atomic_add v143, v41, s[34:35] sc1
    s_mov_b64 exec, -1
    s_setprio 0
    s_waitcnt lgkmcnt(0)
    v_mfma_f32_32x32x16_bf16 v[176:191], v[224:227], v[192:195], 0
    v_mfma_f32_32x32x16_bf16 v[176:191], v[228:231], v[196:199], v[176:191]
    v_mfma_f32_32x32x16_bf16 v[176:191], v[232:235], v[200:203], v[176:191]
    v_mfma_f32_32x32x16_bf16 v[176:191], v[236:239], v[204:207], v[176:191]
    v_mfma_f32_32x32x16_bf16 v[176:191], v[240:243], v[208:211], v[176:191]
    v_mfma_f32_32x32x16_bf16 v[176:191], v[244:247], v[212:215], v[176:191]
    v_mfma_f32_32x32x16_bf16 v[176:191], v[248:251], v[216:219], v[176:191]
    v_mfma_f32_32x32x16_bf16 v[176:191], v[252:255], v[220:223], v[176:191]
    s_setprio 2
    s_nop 8
    s_cmp_eq_u32 s50, 0
    s_cbranch_scc0 L_k1_14
    ds_write_b128 v28, v[184:187]
    ds_write_b128 v28, v[188:191] offset:1024
    s_mov_b64 exec, 1
    ds_add_u32 v24, v41
    s_mov_b64 exec, -1
    s_mov_b32 s62, 1600000
L_lw_16:
    ds_read_b32 v43, v24
    s_sub_u32 s62, s62, 1
    s_cbranch_scc1 L_lwd_17
    s_waitcnt lgkmcnt(0)
    v_readfirstlane_b32 s63, v43
    s_nop 1
    s_cmp_ge_u32 s63, 2
    s_cbranch_scc0 L_lw_16
L_lwd_17:
    s_waitcnt lgkmcnt(0)
    ds_read_b128 v[64:67], v29
    ds_read_b128 v[68:71], v29 offset:1024
    s_waitcnt lgkmcnt(0)
    v_add_f32 v64, v64, v176
    v_add_f32 v65, v65, v177
    v_add_f32 v66, v66, v178
    v_add_f32 v67, v67, v179
    v_add_f32 v68, v68, v180
    v_add_f32 v69, v69, v181
    v_add_f32 v70, v70, v182
    v_add_f32 v71, v71, v183
    s_mov_b64 exec, 0xff
    ds_write_b128 v142, v[12:15]
    s_mov_b64 exec, 1
    v_add_f32 v64, s55, v64
    s_mov_b64 exec, -1
    v_cvt_pk_bf16_f32 v72, v64, v65
    v_cvt_pk_bf16_f32 v73, v66, v67
    v_cvt_pk_bf16_f32 v74, v68, v69
    v_cvt_pk_bf16_f32 v75, v70, v71
    v_cvt_pk_bf16_f32 v86, v71, v71
    ds_write2_b32 v141, v86, v86 offset0:2 offset1:3
    ds_write_b64 v141, v[72:73]
    ds_read_b64 v[76:77], v141 offset:8
    ds_write_b128 v128, v[72:75]
    s_waitcnt lgkmcnt(1)
    v_alignbit_b32 v80, v73, v72, 16
    v_alignbit_b32 v81, v74, v73, 16
    v_alignbit_b32 v82, v75, v74, 16
    v_alignbit_b32 v83, v76, v75, 16
    v_alignbit_b32 v84, v77, v76, 16
    ds_write_b128 v131, v[80:83]
    ds_write2_b32 v134, v73, v74 offset0:0 offset1:1
    ds_write2_b32 v134, v75, v76 offset0:2 offset1:3
    ds_write2_b32 v137, v81, v82 offset0:0 offset1:1
    ds_write2_b32 v137, v83, v84 offset0:2 offset1:3
    s_mov_b64 exec, 1
    v_lshlrev_b32 v86, 16, v72
    ds_write_b32 v142, v86 offset:4188
    ds_write_b32 v142, v72 offset:8348
    ds_write_b32 v142, v86 offset:12504
    ds_write_b32 v142, v80 offset:12508
    s_mov_b64 exec, -1
    s_branch L_k2_15
L_k1_14:
    ds_write_b128 v28, v[176:179]
    ds_write_b128 v28, v[180:183] offset:1024
    s_mov_b64 exec, 1
    ds_add_u32 v24, v41
    s_mov_b64 exec, -1
    s_mov_b32 s62, 1600000
L_lw_18:
    ds_read_b32 v43, v24
    s_sub_u32 s62, s62, 1
    s_cbranch_scc1 L_lwd_19
    s_waitcnt lgkmcnt(0)
    v_readfirstlane_b32 s63, v43
    s_nop 1
    s_cmp_ge_u32 s63, 2
    s_cbranch_scc0 L_lw_18
L_lwd_19:
    s_waitcnt lgkmcnt(0)
    ds_read_b128 v[64:67], v29
    ds_read_b128 v[68:71], v29 offset:1024
    s_waitcnt lgkmcnt(0)
    v_add_f32 v64, v64, v184
    v_add_f32 v65, v65, v185
    v_add_f32 v66, v66, v186
    v_add_f32 v67, v67, v187
    v_add_f32 v68, v68, v188
    v_add_f32 v69, v69, v189
    v_add_f32 v70, v70, v190
    v_cvt_pk_bf16_f32 v72, v64, v64
    v_cvt_pk_bf16_f32 v73, v64, v65
    v_cvt_pk_bf16_f32 v74, v65, v65
    v_cvt_pk_bf16_f32 v75, v65, v66
    v_cvt_pk_bf16_f32 v76, v66, v66
    ds_write2_b32 v128, v72, v73 offset0:0 offset1:1
    ds_write2_b32 v128, v74, v76 offset0:2 offset1:3
    ds_write2_b32 v131, v72, v74 offset0:0 offset1:1
    ds_write2_b32 v131, v75, v76 offset0:2 offset1:3
    ds_write2_b32 v134, v73, v74 offset0:0 offset1:1
    ds_write2_b32 v134, v76, v76 offset0:2 offset1:3
    ds_write2_b32 v137, v74, v75 offset0:0 offset1:1
    ds_write2_b32 v137, v76, v76 offset0:2 offset1:3
    v_cndmask_b32 v77, v67, v68, s[94:95]
    v_cvt_pk_bf16_f32 v78, v67, v67
    v_cvt_pk_bf16_f32 v81, v68, v68
    v_cvt_pk_bf16_f32 v79, v67, v77
    v_cvt_pk_bf16_f32 v80, v77, v68
    ds_write2_b32 v129, v78, v78 offset0:0 offset1:1
    ds_write2_b32 v129, v80, v81 offset0:2 offset1:3
    ds_write2_b32 v132, v78, v79 offset0:0 offset1:1
    ds_write2_b32 v132, v81, v81 offset0:2 offset1:3
    ds_write2_b32 v135, v78, v80 offset0:0 offset1:1
    ds_write2_b32 v135, v81, v81 offset0:2 offset1:3
    ds_write2_b32 v138, v79, v81 offset0:0 offset1:1
    ds_write2_b32 v138, v81, v81 offset0:2 offset1:3
    v_cndmask_b32 v82, v69, v70, s[94:95]
    v_cvt_pk_bf16_f32 v83, v69, v69
    v_cvt_pk_bf16_f32 v86, v70, v70
    v_cvt_pk_bf16_f32 v84, v69, v82
    v_cvt_pk_bf16_f32 v85, v82, v70
    ds_write2_b32 v130, v83, v83 offset0:0 offset1:1
    ds_write2_b32 v130, v85, v86 offset0:2 offset1:3
    ds_write2_b32 v133, v83, v84 offset0:0 offset1:1
    ds_write2_b32 v133, v86, v86 offset0:2 offset1:3
    ds_write2_b32 v136, v83, v85 offset0:0 offset1:1
    ds_write2_b32 v136, v86, v86 offset0:2 offset1:3
    ds_write2_b32 v139, v84, v86 offset0:0 offset1:1
    ds_write2_b32 v139, v86, v86 offset0:2 offset1:3
L_k2_15:
    s_mov_b32 s62, 200000
    s_mov_b64 exec, 1
L_pc_20:
    v_mov_b32 v43, 0
    global_atomic_add v43, v144, v43, s[34:35] sc0 sc1
L_pcc_22:
    s_sub_u32 s62, s62, 1
    s_cbranch_scc1 L_pcd_21
    s_waitcnt vmcnt(0)
    v_readfirstlane_b32 s63, v43
    s_nop 0
    s_cmp_eq_u32 s63, 16
    s_cbranch_scc0 L_pc_20
L_pcd_21:
    s_mov_b64 exec, -1
    global_load_dwordx4 v[12:15], v39, s[46:47] sc1
    global_load_dwordx4 v[16:19], v39, s[46:47] offset:2048 sc1
    s_waitcnt vmcnt(0)
    ds_write_b128 v27, v[12:15] offset:512
    ds_write_b128 v27, v[16:19]
    s_mov_b64 exec, 1
    ds_add_u32 v42, v41
    s_mov_b64 exec, -1
    s_mov_b32 s62, 1600000
L_lw_23:
    ds_read_b32 v43, v42
    s_sub_u32 s62, s62, 1
    s_cbranch_scc1 L_lwd_24
    s_waitcnt lgkmcnt(0)
    v_readfirstlane_b32 s63, v43
    s_nop 1
    s_cmp_ge_u32 s63, 4
    s_cbranch_scc0 L_lw_23
L_lwd_24:
    s_waitcnt lgkmcnt(0)
    ds_read_b64 v[96:97], v25 offset:0
    ds_read_b64 v[98:99], v25 offset:8
    ds_read_b128 v[128:131], v26 offset:3584
    ds_read_b64 v[100:101], v25 offset:512
    ds_read_b64 v[102:103], v25 offset:520
    ds_read_b128 v[132:135], v26 offset:3072
    ds_read_b64 v[104:105], v25 offset:1024
    ds_read_b64 v[106:107], v25 offset:1032
    ds_read_b128 v[136:139], v26 offset:2560
    ds_read_b64 v[108:109], v25 offset:1536
    ds_read_b64 v[110:111], v25 offset:1544
    ds_read_b128 v[140:143], v26 offset:2048
    ds_read_b64 v[112:113], v25 offset:2048
    ds_read_b64 v[114:115], v25 offset:2056
    ds_read_b128 v[144:147], v26 offset:1536
    ds_read_b64 v[116:117], v25 offset:2560
    ds_read_b64 v[118:119], v25 offset:2568
    ds_read_b128 v[148:151], v26 offset:1024
    ds_read_b64 v[120:121], v25 offset:3072
    ds_read_b64 v[122:123], v25 offset:3080
    ds_read_b128 v[152:155], v26 offset:512
    ds_read_b64 v[124:125], v25 offset:3584
    ds_read_b64 v[126:127], v25 offset:3592
    ds_read_b128 v[156:159], v26 offset:0
    s_setprio 0
    s_waitcnt lgkmcnt(0)
    v_mfma_f32_16x16x32_bf16 v[64:67], v[96:99], v[128:131], 0
    ds_read_b64 v[192:193], v25 offset:64
    v_mfma_f32_16x16x32_bf16 v[68:71], v[96:99], v[132:135], 0
    ds_read_b64 v[194:195], v25 offset:72
    v_mfma_f32_16x16x32_bf16 v[72:75], v[96:99], v[136:139], 0
    ds_read_b128 v[224:227], v26 offset:3648
    v_mfma_f32_16x16x32_bf16 v[76:79], v[96:99], v[140:143], 0
    ds_read_b64 v[196:197], v25 offset:576
    v_mfma_f32_16x16x32_bf16 v[80:83], v[96:99], v[144:147], 0
    ds_read_b64 v[198:199], v25 offset:584
    v_mfma_f32_16x16x32_bf16 v[84:87], v[96:99], v[148:151], 0
    ds_read_b128 v[228:231], v26 offset:3136
    v_mfma_f32_16x16x32_bf16 v[88:91], v[96:99], v[152:155], 0
    ds_read_b64 v[200:201], v25 offset:1088
    v_mfma_f32_16x16x32_bf16 v[92:95], v[96:99], v[156:159], 0
    ds_read_b64 v[202:203], v25 offset:1096
    v_mfma_f32_16x16x32_bf16 v[68:71], v[100:103], v[128:131], v[68:71]
    ds_read_b128 v[232:235], v26 offset:2624
    v_mfma_f32_16x16x32_bf16 v[72:75], v[100:103], v[132:135], v[72:75]
    ds_read_b64 v[204:205], v25 offset:1600
    v_mfma_f32_16x16x32_bf16 v[76:79], v[100:103], v[136:139], v[76:79]
    ds_read_b64 v[206:207], v25 offset:1608
    v_mfma_f32_16x16x32_bf16 v[80:83], v[100:103], v[140:143], v[80:83]
    ds_read_b128 v[236:239], v26 offset:2112
    v_mfma_f32_16x16x32_bf16 v[84:87], v[100:103], v[144:147], v[84:87]
    ds_read_b64 v[208:209], v25 offset:2112
    v_mfma_f32_16x16x32_bf16 v[88:91], v[100:103], v[148:151], v[88:91]
    ds_read_b64 v[210:211], v25 offset:2120
    v_mfma_f32_16x16x32_bf16 v[92:95], v[100:103], v[152:155], v[92:95]
    ds_read_b128 v[240:243], v26 offset:1600
    v_mfma_f32_16x16x32_bf16 v[72:75], v[104:107], v[128:131], v[72:75]
    ds_read_b64 v[212:213], v25 offset:2624
    v_mfma_f32_16x16x32_bf16 v[76:79], v[104:107], v[132:135], v[76:79]
    ds_read_b64 v[214:215], v25 offset:2632
    v_mfma_f32_16x16x32_bf16 v[80:83], v[104:107], v[136:139], v[80:83]
    ds_read_b128 v[244:247], v26 offset:1088
    v_mfma_f32_16x16x32_bf16 v[84:87], v[104:107], v[140:143], v[84:87]
    ds_read_b64 v[216:217], v25 offset:3136
    v_mfma_f32_16x16x32_bf16 v[88:91], v[104:107], v[144:147], v[88:91]
    ds_read_b64 v[218:219], v25 offset:3144
    v_mfma_f32_16x16x32_bf16 v[92:95], v[104:107], v[148:151], v[92:95]
    ds_read_b128 v[248:251], v26 offset:576
    v_mfma_f32_16x16x32_bf16 v[76:79], v[108:111], v[128:131], v[76:79]
    ds_read_b64 v[220:221], v25 offset:3648
    v_mfma_f32_16x16x32_bf16 v[80:83], v[108:111], v[132:135], v[80:83]
    ds_read_b64 v[222:223], v25 offset:3656
    v_mfma_f32_16x16x32_bf16 v[84:87], v[108:111], v[136:139], v[84:87]
    ds_read_b128 v[252:255], v26 offset:64
    v_mfma_f32_16x16x32_bf16 v[88:91], v[108:111], v[140:143], v[88:91]
    v_mfma_f32_16x16x32_bf16 v[92:95], v[108:111], v[144:147], v[92:95]
    v_mfma_f32_16x16x32_bf16 v[80:83], v[112:115], v[128:131], v[80:83]
    v_mfma_f32_16x16x32_bf16 v[84:87], v[112:115], v[132:135], v[84:87]
    v_mfma_f32_16x16x32_bf16 v[88:91], v[112:115], v[136:139], v[88:91]
    v_mfma_f32_16x16x32_bf16 v[92:95], v[112:115], v[140:143], v[92:95]
    v_mfma_f32_16x16x32_bf16 v[84:87], v[116:119], v[128:131], v[84:87]
    v_mfma_f32_16x16x32_bf16 v[88:91], v[116:119], v[132:135], v[88:91]
    v_mfma_f32_16x16x32_bf16 v[92:95], v[116:119], v[136:139], v[92:95]
    v_mfma_f32_16x16x32_bf16 v[88:91], v[120:123], v[128:131], v[88:91]
    v_mfma_f32_16x16x32_bf16 v[92:95], v[120:123], v[132:135], v[92:95]
    v_mfma_f32_16x16x32_bf16 v[92:95], v[124:127], v[128:131], v[92:95]
    s_waitcnt lgkmcnt(0)
    v_mfma_f32_16x16x32_bf16 v[64:67], v[192:195], v[224:227], v[64:67]
    ds_read_b64 v[96:97], v25 offset:128
    v_mfma_f32_16x16x32_bf16 v[68:71], v[192:195], v[228:231], v[68:71]
    ds_read_b64 v[98:99], v25 offset:136
    v_mfma_f32_16x16x32_bf16 v[72:75], v[192:195], v[232:235], v[72:75]
    ds_read_b128 v[128:131], v26 offset:3712
    v_mfma_f32_16x16x32_bf16 v[76:79], v[192:195], v[236:239], v[76:79]
    ds_read_b64 v[100:101], v25 offset:640
    v_mfma_f32_16x16x32_bf16 v[80:83], v[192:195], v[240:243], v[80:83]
    ds_read_b64 v[102:103], v25 offset:648
    v_mfma_f32_16x16x32_bf16 v[84:87], v[192:195], v[244:247], v[84:87]
    ds_read_b128 v[132:135], v26 offset:3200
    v_mfma_f32_16x16x32_bf16 v[88:91], v[192:195], v[248:251], v[88:91]
    ds_read_b64 v[104:105], v25 offset:1152
    v_mfma_f32_16x16x32_bf16 v[92:95], v[192:195], v[252:255], v[92:95]
    ds_read_b64 v[106:107], v25 offset:1160
    v_mfma_f32_16x16x32_bf16 v[68:71], v[196:199], v[224:227], v[68:71]
    ds_read_b128 v[136:139], v26 offset:2688
    v_mfma_f32_16x16x32_bf16 v[72:75], v[196:199], v[228:231], v[72:75]
    ds_read_b64 v[108:109], v25 offset:1664
    v_mfma_f32_16x16x32_bf16 v[76:79], v[196:199], v[232:235], v[76:79]
    ds_read_b64 v[110:111], v25 offset:1672
    v_mfma_f32_16x16x32_bf16 v[80:83], v[196:199], v[236:239], v[80:83]
    ds_read_b128 v[140:143], v26 offset:2176
    v_mfma_f32_16x16x32_bf16 v[84:87], v[196:199], v[240:243], v[84:87]
    ds_read_b64 v[112:113], v25 offset:2176
    v_mfma_f32_16x16x32_bf16 v[88:91], v[196:199], v[244:247], v[88:91]
    ds_read_b64 v[114:115], v25 offset:2184
    v_mfma_f32_16x16x32_bf16 v[92:95], v[196:199], v[248:251], v[92:95]
    ds_read_b128 v[144:147], v26 offset:1664
    v_mfma_f32_16x16x32_bf16 v[72:75], v[200:203], v[224:227], v[72:75]
    ds_read_b64 v[116:117], v25 offset:2688
    v_mfma_f32_16x16x32_bf16 v[76:79], v[200:203], v[228:231], v[76:79]
    ds_read_b64 v[118:119], v25 offset:2696
    v_mfma_f32_16x16x32_bf16 v[80:83], v[200:203], v[232:235], v[80:83]
    ds_read_b128 v[148:151], v26 offset:1152
    v_mfma_f32_16x16x32_bf16 v[84:87], v[200:203], v[236:239], v[84:87]
    ds_read_b64 v[120:121], v25 offset:3200
    v_mfma_f32_16x16x32_bf16 v[88:91], v[200:203], v[240:243], v[88:91]
    ds_read_b64 v[122:123], v25 offset:3208
    v_mfma_f32_16x16x32_bf16 v[92:95], v[200:203], v[244:247], v[92:95]
    ds_read_b128 v[152:155], v26 offset:640
    v_mfma_f32_16x16x32_bf16 v[76:79], v[204:207], v[224:227], v[76:79]
    ds_read_b64 v[124:125], v25 offset:3712
    v_mfma_f32_16x16x32_bf16 v[80:83], v[204:207], v[228:231], v[80:83]
    ds_read_b64 v[126:127], v25 offset:3720
    v_mfma_f32_16x16x32_bf16 v[84:87], v[204:207], v[232:235], v[84:87]
    ds_read_b128 v[156:159], v26 offset:128
    v_mfma_f32_16x16x32_bf16 v[88:91], v[204:207], v[236:239], v[88:91]
    v_mfma_f32_16x16x32_bf16 v[92:95], v[204:207], v[240:243], v[92:95]
    v_mfma_f32_16x16x32_bf16 v[80:83], v[208:211], v[224:227], v[80:83]
    v_mfma_f32_16x16x32_bf16 v[84:87], v[208:211], v[228:231], v[84:87]
    v_mfma_f32_16x16x32_bf16 v[88:91], v[208:211], v[232:235], v[88:91]
    v_mfma_f32_16x16x32_bf16 v[92:95], v[208:211], v[236:239], v[92:95]
    v_mfma_f32_16x16x32_bf16 v[84:87], v[212:215], v[224:227], v[84:87]
    v_mfma_f32_16x16x32_bf16 v[88:91], v[212:215], v[228:231], v[88:91]
    v_mfma_f32_16x16x32_bf16 v[92:95], v[212:215], v[232:235], v[92:95]
    v_mfma_f32_16x16x32_bf16 v[88:91], v[216:219], v[224:227], v[88:91]
    v_mfma_f32_16x16x32_bf16 v[92:95], v[216:219], v[228:231], v[92:95]
    v_mfma_f32_16x16x32_bf16 v[92:95], v[220:223], v[224:227], v[92:95]
    s_bfm_b64 exec, 32, 0
    global_load_dword v20, v38, s[38:39]
    s_mov_b64 exec, -1
    s_waitcnt lgkmcnt(0)
    v_mfma_f32_16x16x32_bf16 v[64:67], v[96:99], v[128:131], v[64:67]
    ds_read_b64 v[192:193], v25 offset:192
    v_mfma_f32_16x16x32_bf16 v[68:71], v[96:99], v[132:135], v[68:71]
    ds_read_b64 v[194:195], v25 offset:200
    v_mfma_f32_16x16x32_bf16 v[72:75], v[96:99], v[136:139], v[72:75]
    ds_read_b128 v[224:227], v26 offset:3776
    v_mfma_f32_16x16x32_bf16 v[76:79], v[96:99], v[140:143], v[76:79]
    ds_read_b64 v[196:197], v25 offset:704
    v_mfma_f32_16x16x32_bf16 v[80:83], v[96:99], v[144:147], v[80:83]
    ds_read_b64 v[198:199], v25 offset:712
    v_mfma_f32_16x16x32_bf16 v[84:87], v[96:99], v[148:151], v[84:87]
    ds_read_b128 v[228:231], v26 offset:3264
    v_mfma_f32_16x16x32_bf16 v[88:91], v[96:99], v[152:155], v[88:91]
    ds_read_b64 v[200:201], v25 offset:1216
    v_mfma_f32_16x16x32_bf16 v[92:95], v[96:99], v[156:159], v[92:95]
    ds_read_b64 v[202:203], v25 offset:1224
    v_mfma_f32_16x16x32_bf16 v[68:71], v[100:103], v[128:131], v[68:71]
    ds_read_b128 v[232:235], v26 offset:2752
    v_mfma_f32_16x16x32_bf16 v[72:75], v[100:103], v[132:135], v[72:75]
    ds_read_b64 v[204:205], v25 offset:1728
    v_mfma_f32_16x16x32_bf16 v[76:79], v[100:103], v[136:139], v[76:79]
    ds_read_b64 v[206:207], v25 offset:1736
    v_mfma_f32_16x16x32_bf16 v[80:83], v[100:103], v[140:143], v[80:83]
    ds_read_b128 v[236:239], v26 offset:2240
    v_mfma_f32_16x16x32_bf16 v[84:87], v[100:103], v[144:147], v[84:87]
    ds_read_b64 v[208:209], v25 offset:2240
    v_mfma_f32_16x16x32_bf16 v[88:91], v[100:103], v[148:151], v[88:91]
    ds_read_b64 v[210:211], v25 offset:2248
    v_mfma_f32_16x16x32_bf16 v[92:95], v[100:103], v[152:155], v[92:95]
    ds_read_b128 v[240:243], v26 offset:1728
    v_mfma_f32_16x16x32_bf16 v[72:75], v[104:107], v[128:131], v[72:75]
    ds_read_b64 v[212:213], v25 offset:2752
    v_mfma_f32_16x16x32_bf16 v[76:79], v[104:107], v[132:135], v[76:79]
    ds_read_b64 v[214:215], v25 offset:2760
    v_mfma_f32_16x16x32_bf16 v[80:83], v[104:107], v[136:139], v[80:83]
    ds_read_b128 v[244:247], v26 offset:1216
    v_mfma_f32_16x16x32_bf16 v[84:87], v[104:107], v[140:143], v[84:87]
    ds_read_b64 v[216:217], v25 offset:3264
    v_mfma_f32_16x16x32_bf16 v[88:91], v[104:107], v[144:147], v[88:91]
    ds_read_b64 v[218:219], v25 offset:3272
    v_mfma_f32_16x16x32_bf16 v[92:95], v[104:107], v[148:151], v[92:95]
    ds_read_b128 v[248:251], v26 offset:704
    v_mfma_f32_16x16x32_bf16 v[76:79], v[108:111], v[128:131], v[76:79]
    ds_read_b64 v[220:221], v25 offset:3776
    v_mfma_f32_16x16x32_bf16 v[80:83], v[108:111], v[132:135], v[80:83]
    ds_read_b64 v[222:223], v25 offset:3784
    v_mfma_f32_16x16x32_bf16 v[84:87], v[108:111], v[136:139], v[84:87]
    ds_read_b128 v[252:255], v26 offset:192
    v_mfma_f32_16x16x32_bf16 v[88:91], v[108:111], v[140:143], v[88:91]
    v_mfma_f32_16x16x32_bf16 v[92:95], v[108:111], v[144:147], v[92:95]
    v_mfma_f32_16x16x32_bf16 v[80:83], v[112:115], v[128:131], v[80:83]
    v_mfma_f32_16x16x32_bf16 v[84:87], v[112:115], v[132:135], v[84:87]
    v_mfma_f32_16x16x32_bf16 v[88:91], v[112:115], v[136:139], v[88:91]
    v_mfma_f32_16x16x32_bf16 v[92:95], v[112:115], v[140:143], v[92:95]
    v_mfma_f32_16x16x32_bf16 v[84:87], v[116:119], v[128:131], v[84:87]
    v_mfma_f32_16x16x32_bf16 v[88:91], v[116:119], v[132:135], v[88:91]
    v_mfma_f32_16x16x32_bf16 v[92:95], v[116:119], v[136:139], v[92:95]
    v_mfma_f32_16x16x32_bf16 v[88:91], v[120:123], v[128:131], v[88:91]
    v_mfma_f32_16x16x32_bf16 v[92:95], v[120:123], v[132:135], v[92:95]
    v_mfma_f32_16x16x32_bf16 v[92:95], v[124:127], v[128:131], v[92:95]
    s_waitcnt lgkmcnt(0)
    v_mfma_f32_16x16x32_bf16 v[64:67], v[192:195], v[224:227], v[64:67]
    v_mfma_f32_16x16x32_bf16 v[68:71], v[192:195], v[228:231], v[68:71]
    v_mfma_f32_16x16x32_bf16 v[72:75], v[192:195], v[232:235], v[72:75]
    v_mfma_f32_16x16x32_bf16 v[76:79], v[192:195], v[236:239], v[76:79]
    v_mfma_f32_16x16x32_bf16 v[80:83], v[192:195], v[240:243], v[80:83]
    v_mfma_f32_16x16x32_bf16 v[84:87], v[192:195], v[244:247], v[84:87]
    v_mfma_f32_16x16x32_bf16 v[88:91], v[192:195], v[248:251], v[88:91]
    v_mfma_f32_16x16x32_bf16 v[92:95], v[192:195], v[252:255], v[92:95]
    v_mfma_f32_16x16x32_bf16 v[68:71], v[196:199], v[224:227], v[68:71]
    v_mfma_f32_16x16x32_bf16 v[72:75], v[196:199], v[228:231], v[72:75]
    v_mfma_f32_16x16x32_bf16 v[76:79], v[196:199], v[232:235], v[76:79]
    v_mfma_f32_16x16x32_bf16 v[80:83], v[196:199], v[236:239], v[80:83]
    v_mfma_f32_16x16x32_bf16 v[84:87], v[196:199], v[240:243], v[84:87]
    v_mfma_f32_16x16x32_bf16 v[88:91], v[196:199], v[244:247], v[88:91]
    v_mfma_f32_16x16x32_bf16 v[92:95], v[196:199], v[248:251], v[92:95]
    v_mfma_f32_16x16x32_bf16 v[72:75], v[200:203], v[224:227], v[72:75]
    v_mfma_f32_16x16x32_bf16 v[76:79], v[200:203], v[228:231], v[76:79]
    v_mfma_f32_16x16x32_bf16 v[80:83], v[200:203], v[232:235], v[80:83]
    v_mfma_f32_16x16x32_bf16 v[84:87], v[200:203], v[236:239], v[84:87]
    v_mfma_f32_16x16x32_bf16 v[88:91], v[200:203], v[240:243], v[88:91]
    v_mfma_f32_16x16x32_bf16 v[92:95], v[200:203], v[244:247], v[92:95]
    v_mfma_f32_16x16x32_bf16 v[76:79], v[204:207], v[224:227], v[76:79]
    v_mfma_f32_16x16x32_bf16 v[80:83], v[204:207], v[228:231], v[80:83]
    v_mfma_f32_16x16x32_bf16 v[84:87], v[204:207], v[232:235], v[84:87]
    v_mfma_f32_16x16x32_bf16 v[88:91], v[204:207], v[236:239], v[88:91]
    v_mfma_f32_16x16x32_bf16 v[92:95], v[204:207], v[240:243], v[92:95]
    v_mfma_f32_16x16x32_bf16 v[80:83], v[208:211], v[224:227], v[80:83]
    v_mfma_f32_16x16x32_bf16 v[84:87], v[208:211], v[228:231], v[84:87]
    v_mfma_f32_16x16x32_bf16 v[88:91], v[208:211], v[232:235], v[88:91]
    v_mfma_f32_16x16x32_bf16 v[92:95], v[208:211], v[236:239], v[92:95]
    v_mfma_f32_16x16x32_bf16 v[84:87], v[212:215], v[224:227], v[84:87]
    v_mfma_f32_16x16x32_bf16 v[88:91], v[212:215], v[228:231], v[88:91]
    v_mfma_f32_16x16x32_bf16 v[92:95], v[212:215], v[232:235], v[92:95]
    v_mfma_f32_16x16x32_bf16 v[88:91], v[216:219], v[224:227], v[88:91]
    v_mfma_f32_16x16x32_bf16 v[92:95], v[216:219], v[228:231], v[92:95]
    v_mfma_f32_16x16x32_bf16 v[92:95], v[220:223], v[224:227], v[92:95]
    s_setprio 2
    s_nop 5
    s_cmp_eq_u32 s50, 0
    s_cbranch_scc0 L_c1_25
    ds_write_b128 v28, v[80:83] offset:0
    ds_write_b128 v28, v[84:87] offset:1024
    ds_write_b128 v28, v[88:91] offset:2048
    ds_write_b128 v28, v[92:95] offset:3072
    s_mov_b64 exec, 1
    ds_add_u32 v24, v41
    s_mov_b64 exec, -1
    s_mov_b32 s62, 1600000
L_lw_27:
    ds_read_b32 v43, v24
    s_sub_u32 s62, s62, 1
    s_cbranch_scc1 L_lwd_28
    s_waitcnt lgkmcnt(0)
    v_readfirstlane_b32 s63, v43
    s_nop 1
    s_cmp_ge_u32 s63, 4
    s_cbranch_scc0 L_lw_27
L_lwd_28:
    s_waitcnt lgkmcnt(0)
    ds_read_b128 v[96:99], v29 offset:0
    ds_read_b128 v[100:103], v29 offset:1024
    ds_read_b128 v[104:107], v29 offset:2048
    ds_read_b128 v[108:111], v29 offset:3072
    s_waitcnt lgkmcnt(0)
    v_add_f32 v96, v64, v96
    v_add_f32 v97, v65, v97
    v_add_f32 v98, v66, v98
    v_add_f32 v99, v67, v99
    v_add_f32 v100, v68, v100
    v_add_f32 v101, v69, v101
    v_add_f32 v102, v70, v102
    v_add_f32 v103, v71, v103
    v_add_f32 v104, v72, v104
    v_add_f32 v105, v73, v105
    v_add_f32 v106, v74, v106
    v_add_f32 v107, v75, v107
    v_add_f32 v108, v76, v108
    v_add_f32 v109, v77, v109
    v_add_f32 v110, v78, v110
    v_add_f32 v111, v79, v111
    s_branch L_c2_26
L_c1_25:
    ds_write_b128 v28, v[64:67] offset:0
    ds_write_b128 v28, v[68:71] offset:1024
    ds_write_b128 v28, v[72:75] offset:2048
    ds_write_b128 v28, v[76:79] offset:3072
    s_mov_b64 exec, 1
    ds_add_u32 v24, v41
    s_mov_b64 exec, -1
    s_mov_b32 s62, 1600000
L_lw_29:
    ds_read_b32 v43, v24
    s_sub_u32 s62, s62, 1
    s_cbranch_scc1 L_lwd_30
    s_waitcnt lgkmcnt(0)
    v_readfirstlane_b32 s63, v43
    s_nop 1
    s_cmp_ge_u32 s63, 4
    s_cbranch_scc0 L_lw_29
L_lwd_30:
    s_waitcnt lgkmcnt(0)
    ds_read_b128 v[96:99], v29 offset:0
    ds_read_b128 v[100:103], v29 offset:1024
    ds_read_b128 v[104:107], v29 offset:2048
    ds_read_b128 v[108:111], v29 offset:3072
    s_waitcnt lgkmcnt(0)
    v_add_f32 v96, v80, v96
    v_add_f32 v97, v81, v97
    v_add_f32 v98, v82, v98
    v_add_f32 v99, v83, v99
    v_add_f32 v100, v84, v100
    v_add_f32 v101, v85, v101
    v_add_f32 v102, v86, v102
    v_add_f32 v103, v87, v103
    v_add_f32 v104, v88, v104
    v_add_f32 v105, v89, v105
    v_add_f32 v106, v90, v106
    v_add_f32 v107, v91, v107
    v_add_f32 v108, v92, v108
    v_add_f32 v109, v93, v109
    v_add_f32 v110, v94, v110
    v_add_f32 v111, v95, v111
L_c2_26:
    v_cvt_pk_bf16_f32 v112, v96, v97
    v_cvt_pk_bf16_f32 v113, v98, v99
    ds_write_b64 v166, v[112:113] offset:0
    v_cvt_pk_bf16_f32 v114, v100, v101
    v_cvt_pk_bf16_f32 v115, v102, v103
    ds_write_b64 v166, v[114:115] offset:512
    v_cvt_pk_bf16_f32 v116, v104, v105
    v_cvt_pk_bf16_f32 v117, v106, v107
    ds_write_b64 v166, v[116:117] offset:1024
    v_cvt_pk_bf16_f32 v118, v108, v109
    v_cvt_pk_bf16_f32 v119, v110, v111
    ds_write_b64 v166, v[118:119] offset:1536
    ds_read_b128 v[96:99], v29
    ds_read_b128 v[100:103], v29 offset:1024
    s_waitcnt lgkmcnt(1)
    global_store_dwordx4 v30, v[96:99], s[100:101] sc1
    s_add_u32 s100, s100, 524288
    s_addc_u32 s101, s101, 0
    s_waitcnt lgkmcnt(0)
    global_store_dwordx4 v30, v[100:103], s[100:101] sc1
    s_waitcnt vmcnt(0)
    s_bfm_b64 exec, 1, 0
    global_atomic_add v31, v41, s[34:35] sc1
    s_mov_b64 exec, -1
    s_setprio 0
    s_add_u32 m0, s93, 0
    s_mov_b32 s58, 0
    buffer_load_dwordx4 v32, s[12:15], s58 offen offset:0 lds
    s_mov_b32 s58, 15360
    buffer_load_dwordx4 v32, s[12:15], s58 offen offset:1024 lds
    s_mov_b32 s58, 30720
    buffer_load_dwordx4 v32, s[12:15], s58 offen offset:2048 lds
    s_waitcnt vmcnt(2) lgkmcnt(8)
    ds_read_b64_tr_b16 v[128:129], v33 offset:0
    ds_read_b64_tr_b16 v[130:131], v33 offset:512
    s_mov_b32 s58, 46080
    buffer_load_dwordx4 v32, s[12:15], s58 offen offset:3072 lds
    s_waitcnt vmcnt(2) lgkmcnt(8)
    ds_read_b64_tr_b16 v[132:133], v33 offset:1024
    ds_read_b64_tr_b16 v[134:135], v33 offset:1536
    s_add_u32 m0, s93, 4096
    s_mov_b32 s58, 65536
    buffer_load_dwordx4 v32, s[12:15], s58 offen offset:0 lds
    s_waitcnt vmcnt(2) lgkmcnt(8)
    ds_read_b64_tr_b16 v[136:137], v33 offset:2048
    ds_read_b64_tr_b16 v[138:139], v33 offset:2560
    s_mov_b32 s58, 80896
    buffer_load_dwordx4 v32, s[12:15], s58 offen offset:1024 lds
    s_waitcnt vmcnt(2) lgkmcnt(8)
    ds_read_b64_tr_b16 v[140:141], v33 offset:3072
    ds_read_b64_tr_b16 v[142:143], v33 offset:3584
    s_mov_b32 s58, 96256
    buffer_load_dwordx4 v32, s[12:15], s58 offen offset:2048 lds
    s_waitcnt vmcnt(2) lgkmcnt(8)
    ds_read_b64_tr_b16 v[144:145], v33 offset:4096
    ds_read_b64_tr_b16 v[146:147], v33 offset:4608
    s_mov_b32 s58, 111616
    buffer_load_dwordx4 v32, s[12:15], s58 offen offset:3072 lds
    s_waitcnt vmcnt(2) lgkmcnt(8)
    ds_read_b64_tr_b16 v[148:149], v33 offset:5120
    ds_read_b64_tr_b16 v[150:151], v33 offset:5632
    s_add_u32 m0, s93, 8192
    s_mov_b32 s58, 131072
    buffer_load_dwordx4 v32, s[12:15], s58 offen offset:0 lds
    s_waitcnt vmcnt(2) lgkmcnt(8)
    ds_read_b64_tr_b16 v[152:153], v33 offset:6144
    ds_read_b64_tr_b16 v[154:155], v33 offset:6656
    s_mov_b32 s58, 146432
    buffer_load_dwordx4 v32, s[12:15], s58 offen offset:1024 lds
    s_waitcnt vmcnt(2) lgkmcnt(8)
    ds_read_b64_tr_b16 v[156:157], v33 offset:7168
    ds_read_b64_tr_b16 v[158:159], v33 offset:7680
    s_mov_b32 s58, 161792
    buffer_load_dwordx4 v32, s[12:15], s58 offen offset:2048 lds
    s_waitcnt vmcnt(2) lgkmcnt(8)
    ds_read_b64_tr_b16 v[160:161], v33 offset:8192
    ds_read_b64_tr_b16 v[162:163], v33 offset:8704
    s_mov_b32 s58, 177152
    buffer_load_dwordx4 v32, s[12:15], s58 offen offset:3072 lds
    s_waitcnt vmcnt(2) lgkmcnt(8)
    ds_read_b64_tr_b16 v[164:165], v33 offset:9216
    ds_read_b64_tr_b16 v[166:167], v33 offset:9728
    s_add_u32 m0, s93, 0
    s_mov_b32 s58, 196608
    buffer_load_dwordx4 v32, s[12:15], s58 offen offset:0 lds
    s_waitcnt vmcnt(2) lgkmcnt(8)
    ds_read_b64_tr_b16 v[168:169], v33 offset:10240
    ds_read_b64_tr_b16 v[170:171], v33 offset:10752
    s_mov_b32 s58, 211968
    buffer_load_dwordx4 v32, s[12:15], s58 offen offset:1024 lds
    s_waitcnt vmcnt(2) lgkmcnt(8)
    ds_read_b64_tr_b16 v[172:173], v33 offset:11264
    ds_read_b64_tr_b16 v[174:175], v33 offset:11776
    s_mov_b32 s58, 227328
    buffer_load_dwordx4 v32, s[12:15], s58 offen offset:2048 lds
    s_waitcnt vmcnt(2) lgkmcnt(8)
    ds_read_b64_tr_b16 v[176:177], v33 offset:0
    ds_read_b64_tr_b16 v[178:179], v33 offset:512
    s_mov_b32 s58, 242688
    buffer_load_dwordx4 v32, s[12:15], s58 offen offset:3072 lds
    s_waitcnt vmcnt(2) lgkmcnt(8)
    ds_read_b64_tr_b16 v[180:181], v33 offset:1024
    ds_read_b64_tr_b16 v[182:183], v33 offset:1536
    s_add_u32 m0, s93, 4096
    s_mov_b32 s58, 262144
    buffer_load_dwordx4 v32, s[12:15], s58 offen offset:0 lds
    s_waitcnt vmcnt(2) lgkmcnt(8)
    ds_read_b64_tr_b16 v[184:185], v33 offset:2048
    ds_read_b64_tr_b16 v[186:187], v33 offset:2560
    s_mov_b32 s58, 277504
    buffer_load_dwordx4 v32, s[12:15], s58 offen offset:1024 lds
    s_waitcnt vmcnt(2) lgkmcnt(8)
    ds_read_b64_tr_b16 v[188:189], v33 offset:3072
    ds_read_b64_tr_b16 v[190:191], v33 offset:3584
    s_mov_b32 s58, 292864
    buffer_load_dwordx4 v32, s[12:15], s58 offen offset:2048 lds
    s_waitcnt vmcnt(2) lgkmcnt(8)
    ds_read_b64_tr_b16 v[192:193], v33 offset:4096
    ds_read_b64_tr_b16 v[194:195], v33 offset:4608
    s_mov_b32 s58, 308224
    buffer_load_dwordx4 v32, s[12:15], s58 offen offset:3072 lds
    s_waitcnt vmcnt(2) lgkmcnt(8)
    ds_read_b64_tr_b16 v[196:197], v33 offset:5120
    ds_read_b64_tr_b16 v[198:199], v33 offset:5632
    s_add_u32 m0, s93, 8192
    s_mov_b32 s58, 327680
    buffer_load_dwordx4 v32, s[12:15], s58 offen offset:0 lds
    s_waitcnt vmcnt(2) lgkmcnt(8)
    ds_read_b64_tr_b16 v[200:201], v33 offset:6144
    ds_read_b64_tr_b16 v[202:203], v33 offset:6656
    s_mov_b32 s58, 343040
    buffer_load_dwordx4 v32, s[12:15], s58 offen offset:1024 lds
    s_waitcnt vmcnt(2) lgkmcnt(8)
    ds_read_b64_tr_b16 v[204:205], v33 offset:7168
    ds_read_b64_tr_b16 v[206:207], v33 offset:7680
    s_mov_b32 s58, 358400
    buffer_load_dwordx4 v32, s[12:15], s58 offen offset:2048 lds
    s_waitcnt vmcnt(2) lgkmcnt(8)
    ds_read_b64_tr_b16 v[208:209], v33 offset:8192
    ds_read_b64_tr_b16 v[210:211], v33 offset:8704
    s_mov_b32 s58, 373760
    buffer_load_dwordx4 v32, s[12:15], s58 offen offset:3072 lds
    s_waitcnt vmcnt(2) lgkmcnt(8)
    ds_read_b64_tr_b16 v[212:213], v33 offset:9216
    ds_read_b64_tr_b16 v[214:215], v33 offset:9728
    s_add_u32 m0, s93, 0
    s_mov_b32 s58, 393216
    buffer_load_dwordx4 v32, s[12:15], s58 offen offset:0 lds
    s_waitcnt vmcnt(2) lgkmcnt(8)
    ds_read_b64_tr_b16 v[216:217], v33 offset:10240
    ds_read_b64_tr_b16 v[218:219], v33 offset:10752
    s_mov_b32 s58, 408576
    buffer_load_dwordx4 v32, s[12:15], s58 offen offset:1024 lds
    s_waitcnt vmcnt(2) lgkmcnt(8)
    ds_read_b64_tr_b16 v[220:221], v33 offset:11264
    ds_read_b64_tr_b16 v[222:223], v33 offset:11776
    s_mov_b32 s58, 423936
    buffer_load_dwordx4 v32, s[12:15], s58 offen offset:2048 lds
    s_waitcnt vmcnt(2) lgkmcnt(8)
    ds_read_b64_tr_b16 v[224:225], v33 offset:0
    ds_read_b64_tr_b16 v[226:227], v33 offset:512
    s_mov_b32 s58, 439296
    buffer_load_dwordx4 v32, s[12:15], s58 offen offset:3072 lds
    s_waitcnt vmcnt(2) lgkmcnt(8)
    ds_read_b64_tr_b16 v[228:229], v33 offset:1024
    ds_read_b64_tr_b16 v[230:231], v33 offset:1536
    s_add_u32 m0, s93, 4096
    s_mov_b32 s58, 458752
    buffer_load_dwordx4 v32, s[12:15], s58 offen offset:0 lds
    s_waitcnt vmcnt(2) lgkmcnt(8)
    ds_read_b64_tr_b16 v[232:233], v33 offset:2048
    ds_read_b64_tr_b16 v[234:235], v33 offset:2560
    s_mov_b32 s58, 474112
    buffer_load_dwordx4 v32, s[12:15], s58 offen offset:1024 lds
    s_waitcnt vmcnt(2) lgkmcnt(8)
    ds_read_b64_tr_b16 v[236:237], v33 offset:3072
    ds_read_b64_tr_b16 v[238:239], v33 offset:3584
    s_mov_b32 s58, 489472
    buffer_load_dwordx4 v32, s[12:15], s58 offen offset:2048 lds
    s_waitcnt vmcnt(2) lgkmcnt(8)
    ds_read_b64_tr_b16 v[240:241], v33 offset:4096
    ds_read_b64_tr_b16 v[242:243], v33 offset:4608
    s_mov_b32 s58, 504832
    buffer_load_dwordx4 v32, s[12:15], s58 offen offset:3072 lds
    s_waitcnt vmcnt(2) lgkmcnt(8)
    ds_read_b64_tr_b16 v[244:245], v33 offset:5120
    ds_read_b64_tr_b16 v[246:247], v33 offset:5632
    s_waitcnt vmcnt(1) lgkmcnt(8)
    ds_read_b64_tr_b16 v[248:249], v33 offset:6144
    ds_read_b64_tr_b16 v[250:251], v33 offset:6656
    s_waitcnt vmcnt(0) lgkmcnt(8)
    ds_read_b64_tr_b16 v[252:253], v33 offset:7168
    ds_read_b64_tr_b16 v[254:255], v33 offset:7680
    s_waitcnt lgkmcnt(0)
    s_setprio 2
    s_mov_b32 s62, 200000
    s_mov_b64 exec, 1
L_pc_31:
    v_mov_b32 v43, 0
    global_atomic_add v43, v34, v43, s[34:35] sc0 sc1
L_pcc_33:
    s_sub_u32 s62, s62, 1
    s_cbranch_scc1 L_pcd_32
    s_waitcnt vmcnt(0)
    v_readfirstlane_b32 s63, v43
    s_nop 0
    s_cmp_eq_u32 s63, 32
    s_cbranch_scc0 L_pc_31
L_pcd_32:
    s_mov_b64 exec, -1
    s_setprio 0
    global_load_short_d16_hi v48, v35, s[46:47] offset:0 sc1
    global_load_short_d16_hi v49, v35, s[46:47] offset:64 sc1
    global_load_short_d16_hi v50, v35, s[46:47] offset:128 sc1
    global_load_short_d16_hi v51, v35, s[46:47] offset:192 sc1
    global_load_short_d16_hi v52, v35, s[46:47] offset:512 sc1
    global_load_short_d16_hi v53, v35, s[46:47] offset:576 sc1
    global_load_short_d16_hi v54, v35, s[46:47] offset:640 sc1
    global_load_short_d16_hi v55, v35, s[46:47] offset:704 sc1
    s_waitcnt vmcnt(7)
    global_load_short_d16_hi v56, v35, s[46:47] offset:1024 sc1
    s_waitcnt vmcnt(7)
    global_load_short_d16_hi v57, v35, s[46:47] offset:1088 sc1
    s_waitcnt vmcnt(7)
    global_load_short_d16_hi v58, v35, s[46:47] offset:1152 sc1
    s_waitcnt vmcnt(7)
    global_load_short_d16_hi v59, v35, s[46:47] offset:1216 sc1
    s_waitcnt vmcnt(7)
    global_load_short_d16_hi v60, v35, s[46:47] offset:1536 sc1
    s_waitcnt vmcnt(7)
    global_load_short_d16_hi v61, v35, s[46:47] offset:1600 sc1
    s_waitcnt vmcnt(7)
    global_load_short_d16_hi v62, v35, s[46:47] offset:1664 sc1
    s_waitcnt vmcnt(7)
    global_load_short_d16_hi v63, v35, s[46:47] offset:1728 sc1
    s_mov_b32 s56, 0x01010101
    s_mov_b32 s62, 1600000
    s_waitcnt vmcnt(0) lgkmcnt(0)
    s_setprio 0
    s_barrier
    v_mul_f32 v48, v45, v48
    v_mul_f32 v49, v45, v49
    v_mul_f32 v50, v45, v50
    v_mul_f32 v51, v45, v51
    v_mul_f32 v52, v45, v52
    v_mul_f32 v53, v45, v53
    v_mul_f32 v54, v45, v54
    v_mul_f32 v55, v45, v55
    v_mul_f32 v56, v45, v56
    v_mul_f32 v57, v45, v57
    v_mul_f32 v58, v45, v58
    v_mul_f32 v59, v45, v59
    v_mul_f32 v60, v45, v60
    v_mul_f32 v61, v45, v61
    v_mul_f32 v62, v45, v62
    v_mul_f32 v63, v45, v63
    s_mul_i32 s58, s48, 2560
    v_and_b32 v7, 31, v1
    v_mul_u32_u24 v7, 80, v7
    v_lshrrev_b32 v4, 5, v1
    v_lshlrev_b32 v4, 3, v4
    v_add3_u32 v4, v4, v7, s58
    v_lshrrev_b32 v7, 2, v1
    v_lshl_add_u32 v46, v7, 10, s60
    v_mul_u32_u24 v7, 80, v7
    v_and_b32 v5, 3, v1
    v_lshlrev_b32 v5, 4, v5
    v_add_u32 v46, v46, v5
    v_add_u32 v6, 0x4000, v46
    v_add3_u32 v5, v5, v7, s58
L_fwait:
    ds_read_b32 v43, v42 offset:12
    s_sub_u32 s62, s62, 1
    s_cbranch_scc1 L_fend
    s_waitcnt lgkmcnt(0)
    v_readfirstlane_b32 s58, v43
    s_nop 0
    s_and_b32 s58, s58, s56
    s_cbranch_scc0 L_fwait
    s_ff1_i32_b32 s58, s58
    v_lshl_add_u32 v2, s58, 10, v47
    ds_read_b128 v[64:67], v2 offset:0
    ds_read_b128 v[68:71], v2 offset:1024
    ds_read_b128 v[72:75], v2 offset:2048
    ds_read_b128 v[76:79], v2 offset:3072
L_fdisp:
    ds_read_b128 v[80:83], v2 offset:4096
    ds_read_b128 v[84:87], v2 offset:5120
    ds_read_b128 v[88:91], v2 offset:6144
    ds_read_b128 v[92:95], v2 offset:7168
    ds_read_b32 v43, v42 offset:12
    s_bitset0_b32 s56, s58
    s_cmp_eq_u32 s58, 8
    s_cbranch_scc1 L_fb1
    s_cmp_eq_u32 s58, 16
    s_cbranch_scc1 L_fb2
    s_cmp_eq_u32 s58, 24
    s_cbranch_scc1 L_fb3
L_fb0:
    s_waitcnt lgkmcnt(8)
    v_mfma_f32_32x32x16_bf16 v[96:111], v[128:131], v[64:67], 0
    s_waitcnt lgkmcnt(7)
    v_mfma_f32_32x32x16_bf16 v[96:111], v[132:135], v[68:71], v[96:111]
    s_waitcnt lgkmcnt(6)
    v_mfma_f32_32x32x16_bf16 v[96:111], v[136:139], v[72:75], v[96:111]
    s_waitcnt lgkmcnt(5)
    v_mfma_f32_32x32x16_bf16 v[96:111], v[140:143], v[76:79], v[96:111]
    s_waitcnt lgkmcnt(0)
    v_mfma_f32_32x32x16_bf16 v[96:111], v[144:147], v[80:83], v[96:111]
    v_readfirstlane_b32 s58, v43
    s_nop 0
    s_and_b32 s58, s58, s56
    s_cbranch_scc0 L_fs0
    s_ff1_i32_b32 s58, s58
    v_lshl_add_u32 v2, s58, 10, v47
    ds_read_b128 v[64:67], v2 offset:0
    ds_read_b128 v[68:71], v2 offset:1024
    ds_read_b128 v[72:75], v2 offset:2048
    ds_read_b128 v[76:79], v2 offset:3072
L_fs0:
    v_mfma_f32_32x32x16_bf16 v[96:111], v[148:151], v[84:87], v[96:111]
    v_mfma_f32_32x32x16_bf16 v[96:111], v[152:155], v[88:91], v[96:111]
    v_mfma_f32_32x32x16_bf16 v[96:111], v[156:159], v[92:95], v[96:111]
    s_cbranch_scc1 L_fdisp
    s_branch L_fnext
L_fb1:
    s_waitcnt lgkmcnt(8)
    v_mfma_f32_32x32x16_bf16 v[112:127], v[160:163], v[64:67], 0
    s_waitcnt lgkmcnt(7)
    v_mfma_f32_32x32x16_bf16 v[112:127], v[164:167], v[68:71], v[112:127]
    s_waitcnt lgkmcnt(6)
    v_mfma_f32_32x32x16_bf16 v[112:127], v[168:171], v[72:75], v[112:127]
    s_waitcnt lgkmcnt(5)
    v_mfma_f32_32x32x16_bf16 v[112:127], v[172:175], v[76:79], v[112:127]
    s_waitcnt lgkmcnt(0)
    v_mfma_f32_32x32x16_bf16 v[112:127], v[176:179], v[80:83], v[112:127]
    v_readfirstlane_b32 s58, v43
    s_nop 0
    s_and_b32 s58, s58, s56
    s_cbranch_scc0 L_fs1
    s_ff1_i32_b32 s58, s58
    v_lshl_add_u32 v2, s58, 10, v47
    ds_read_b128 v[64:67], v2 offset:0
    ds_read_b128 v[68:71], v2 offset:1024
    ds_read_b128 v[72:75], v2 offset:2048
    ds_read_b128 v[76:79], v2 offset:3072
L_fs1:
    v_mfma_f32_32x32x16_bf16 v[112:127], v[180:183], v[84:87], v[112:127]
    v_mfma_f32_32x32x16_bf16 v[112:127], v[184:187], v[88:91], v[112:127]
    v_mfma_f32_32x32x16_bf16 v[112:127], v[188:191], v[92:95], v[112:127]
    s_cbranch_scc1 L_fdisp
    s_branch L_fnext
L_fb2:
    s_waitcnt lgkmcnt(8)
    v_mfma_f32_32x32x16_bf16 v[8:23], v[192:195], v[64:67], 0
    s_waitcnt lgkmcnt(7)
    v_mfma_f32_32x32x16_bf16 v[8:23], v[196:199], v[68:71], v[8:23]
    s_waitcnt lgkmcnt(6)
    v_mfma_f32_32x32x16_bf16 v[8:23], v[200:203], v[72:75], v[8:23]
    s_waitcnt lgkmcnt(5)
    v_mfma_f32_32x32x16_bf16 v[8:23], v[204:207], v[76:79], v[8:23]
    s_waitcnt lgkmcnt(0)
    v_mfma_f32_32x32x16_bf16 v[8:23], v[208:211], v[80:83], v[8:23]
    v_readfirstlane_b32 s58, v43
    s_nop 0
    s_and_b32 s58, s58, s56
    s_cbranch_scc0 L_fs2
    s_ff1_i32_b32 s58, s58
    v_lshl_add_u32 v2, s58, 10, v47
    ds_read_b128 v[64:67], v2 offset:0
    ds_read_b128 v[68:71], v2 offset:1024
    ds_read_b128 v[72:75], v2 offset:2048
    ds_read_b128 v[76:79], v2 offset:3072
L_fs2:
    v_mfma_f32_32x32x16_bf16 v[8:23], v[212:215], v[84:87], v[8:23]
    v_mfma_f32_32x32x16_bf16 v[8:23], v[216:219], v[88:91], v[8:23]
    v_mfma_f32_32x32x16_bf16 v[8:23], v[220:223], v[92:95], v[8:23]
    s_cbranch_scc1 L_fdisp
    s_branch L_fnext
L_fb3:
    s_waitcnt lgkmcnt(8)
    v_mfma_f32_32x32x16_bf16 v[24:39], v[224:227], v[64:67], 0
    s_waitcnt lgkmcnt(7)
    v_mfma_f32_32x32x16_bf16 v[24:39], v[228:231], v[68:71], v[24:39]
    s_waitcnt lgkmcnt(6)
    v_mfma_f32_32x32x16_bf16 v[24:39], v[232:235], v[72:75], v[24:39]
    s_waitcnt lgkmcnt(5)
    v_mfma_f32_32x32x16_bf16 v[24:39], v[236:239], v[76:79], v[24:39]
    s_waitcnt lgkmcnt(0)
    v_mfma_f32_32x32x16_bf16 v[24:39], v[240:243], v[80:83], v[24:39]
    v_readfirstlane_b32 s58, v43
    s_nop 0
    s_and_b32 s58, s58, s56
    s_cbranch_scc0 L_fs3
    s_ff1_i32_b32 s58, s58
    v_lshl_add_u32 v2, s58, 10, v47
    ds_read_b128 v[64:67], v2 offset:0
    ds_read_b128 v[68:71], v2 offset:1024
    ds_read_b128 v[72:75], v2 offset:2048
    ds_read_b128 v[76:79], v2 offset:3072
L_fs3:
    v_mfma_f32_32x32x16_bf16 v[24:39], v[244:247], v[84:87], v[24:39]
    v_mfma_f32_32x32x16_bf16 v[24:39], v[248:251], v[88:91], v[24:39]
    v_mfma_f32_32x32x16_bf16 v[24:39], v[252:255], v[92:95], v[24:39]
    s_cbranch_scc1 L_fdisp
L_fnext:
    s_cmp_lg_u32 s56, 0
    s_cbranch_scc1 L_fwait
L_fend:
    s_nop 8
    v_pk_add_f32 v[96:97], v[96:97], v[112:113]
    v_pk_add_f32 v[98:99], v[98:99], v[114:115]
    v_pk_add_f32 v[100:101], v[100:101], v[116:117]
    v_pk_add_f32 v[102:103], v[102:103], v[118:119]
    v_pk_add_f32 v[8:9], v[8:9], v[24:25]
    v_pk_add_f32 v[10:11], v[10:11], v[26:27]
    v_pk_add_f32 v[12:13], v[12:13], v[28:29]
    v_pk_add_f32 v[14:15], v[14:15], v[30:31]
    v_pk_add_f32 v[96:97], v[96:97], v[8:9]
    v_pk_add_f32 v[98:99], v[98:99], v[10:11]
    v_pk_add_f32 v[100:101], v[100:101], v[12:13]
    v_pk_add_f32 v[102:103], v[102:103], v[14:15]
    v_pk_fma_f32 v[96:97], v[96:97], v[44:45], v[48:49] op_sel_hi:[1,0,1]
    v_pk_fma_f32 v[98:99], v[98:99], v[44:45], v[50:51] op_sel_hi:[1,0,1]
    v_pk_fma_f32 v[100:101], v[100:101], v[44:45], v[52:53] op_sel_hi:[1,0,1]
    v_pk_fma_f32 v[102:103], v[102:103], v[44:45], v[54:55] op_sel_hi:[1,0,1]
    v_cvt_pk_bf16_f32 v64, v96, v97
    v_cvt_pk_bf16_f32 v65, v98, v99
    ds_write_b64 v4, v[64:65] offset:0
    v_cvt_pk_bf16_f32 v66, v100, v101
    v_cvt_pk_bf16_f32 v67, v102, v103
    ds_write_b64 v4, v[66:67] offset:16
    v_pk_add_f32 v[104:105], v[104:105], v[120:121]
    v_pk_add_f32 v[106:107], v[106:107], v[122:123]
    v_pk_add_f32 v[108:109], v[108:109], v[124:125]
    v_pk_add_f32 v[110:111], v[110:111], v[126:127]
    v_pk_add_f32 v[16:17], v[16:17], v[32:33]
    v_pk_add_f32 v[18:19], v[18:19], v[34:35]
    v_pk_add_f32 v[20:21], v[20:21], v[36:37]
    v_pk_add_f32 v[22:23], v[22:23], v[38:39]
    v_pk_add_f32 v[104:105], v[104:105], v[16:17]
    v_pk_add_f32 v[106:107], v[106:107], v[18:19]
    v_pk_add_f32 v[108:109], v[108:109], v[20:21]
    v_pk_add_f32 v[110:111], v[110:111], v[22:23]
    v_pk_fma_f32 v[104:105], v[104:105], v[44:45], v[56:57] op_sel_hi:[1,0,1]
    v_pk_fma_f32 v[106:107], v[106:107], v[44:45], v[58:59] op_sel_hi:[1,0,1]
    v_pk_fma_f32 v[108:109], v[108:109], v[44:45], v[60:61] op_sel_hi:[1,0,1]
    v_pk_fma_f32 v[110:111], v[110:111], v[44:45], v[62:63] op_sel_hi:[1,0,1]
    v_cvt_pk_bf16_f32 v68, v104, v105
    v_cvt_pk_bf16_f32 v69, v106, v107
    ds_write_b64 v4, v[68:69] offset:32
    v_cvt_pk_bf16_f32 v70, v108, v109
    v_cvt_pk_bf16_f32 v71, v110, v111
    ds_write_b64 v4, v[70:71] offset:48
    ds_read_b128 v[72:75], v5
    ds_read_b128 v[76:79], v5 offset:1280
    s_waitcnt lgkmcnt(1)
    global_store_dwordx4 v46, v[72:75], s[42:43] sc1
    s_waitcnt lgkmcnt(0)
    global_store_dwordx4 v6, v[76:79], s[42:43] sc1
    s_endpgm
L_end:
    s_endpgm
.section .rodata,"a"
.p2align 6
.amdhsa_kernel gated_mix__ssm_conv_s4__mha_block__prompt_kernel
  .amdhsa_next_free_vgpr 256
  .amdhsa_next_free_sgpr 102
  .amdhsa_accum_offset 256
  .amdhsa_group_segment_fixed_size 0
  .amdhsa_kernarg_size 128
  .amdhsa_user_sgpr_count 2
  .amdhsa_user_sgpr_kernarg_segment_ptr 1
  .amdhsa_system_sgpr_workgroup_id_x 1
.end_amdhsa_kernel
```
